```python
import torch

def _softmax(x, axis=-1):
    return torch.softmax(x, dim=axis)
def _gelu(x):
    return torch.nn.functional.gelu(x, approximate="tanh")
def _silu(x):
    return torch.nn.functional.silu(x)
def _sigmoid(x):
    return torch.sigmoid(x)
def _layernorm(x, axis=-1, eps=1e-5):
    m = x.mean(dim=axis, keepdim=True)
    v = x.var(dim=axis, keepdim=True, unbiased=False)
    return (x - m) / torch.sqrt(v + eps)
def _scatter_add(tgt, idx, src, axis=0):
    return tgt.clone().index_add_(axis, idx, src)
def _segment_sum(src, seg, n):
    out = torch.zeros((n,) + src.shape[1:], dtype=src.dtype)
    return out.index_add_(0, seg, src)
def _pad(x, pw):
    flat = tuple(v for pair in reversed(pw) for v in pair)
    return torch.nn.functional.pad(x, flat)

kernel_name = 'gated_mix__linear_kernel_hedgehog__grouped_kv_mqa__prompt'

def setup_inputs():

    _w = (lambda a: (lambda t: t.to(torch.bfloat16) if t.is_floating_point() else t)(torch.as_tensor(a)))
    def _A_setup():
        B, S, D, H = 1, 2048, 448, 16
        Dh = D // H
        return {
            "x": _w((lambda *s: torch.randn(*s, dtype=torch.bfloat16) * 0.05)(B, S, D)),
            "wqkv": _w((lambda *s: torch.randn(*s, dtype=torch.bfloat16) * 1.6)(D, 3 * D)),
            "w_phi": _w((lambda *s: torch.randn(*s, dtype=torch.bfloat16) * 1.6)(H, Dh, Dh) * (Dh ** -0.5)),
            "wo": _w((lambda *s: torch.randn(*s, dtype=torch.bfloat16) * 0.05)(D, D)),
        }
    _A_in = _A_setup()

    def _B_setup():
        B, S, D, H = 1, 2048, 448, 16
        Dh = D // H
        return {
            "x": _w((lambda *s: torch.randn(*s, dtype=torch.bfloat16) * 0.05)(B, S, D)),
            "wq": _w((lambda *s: torch.randn(*s, dtype=torch.bfloat16) * 1.6)(D, H * Dh)),
            "wk": _w((lambda *s: torch.randn(*s, dtype=torch.bfloat16) * 1.6)(D, Dh)),
            "wv": _w((lambda *s: torch.randn(*s, dtype=torch.bfloat16) * 0.05)(D, Dh)),
            "wo": _w((lambda *s: torch.randn(*s, dtype=torch.bfloat16) * 0.05)(H * Dh, D)),
        }
    _B_in = _B_setup()

    return {
        "A_x": _A_in["x"],
        "A_wqkv": _A_in["wqkv"],
        "A_w_phi": _A_in["w_phi"],
        "A_wo": _A_in["wo"],
        "B_x": _B_in["x"],
        "B_wq": _B_in["wq"],
        "B_wk": _B_in["wk"],
        "B_wv": _B_in["wv"],
        "B_wo": _B_in["wo"],
        "gate_w": _w((lambda *s: torch.randn(*s, dtype=torch.bfloat16) * 0.05)(448) * 16.0),
    }

def reference(A_x, A_wqkv, A_w_phi, A_wo, B_x, B_wq, B_wk, B_wv, B_wo, gate_w):
    def _A_ref(x, wqkv, w_phi, wo):
        B, S, D = x.shape
        H = 16; Dh = D // H
        qkv = (lambda x, *d: x.permute(*d))((x @ wqkv).reshape(B, S, 3, H, Dh), 2, 0, 3, 1, 4)
        q, k, v = qkv[0], qkv[1], qkv[2]
        pq = torch.einsum("bhsd,hdf->bhsf", q, w_phi)
        pk = torch.einsum("bhsd,hdf->bhsf", k, w_phi)
        phi_q = torch.concatenate([_softmax(pq, axis=-1), _softmax(-pq, axis=-1)], axis=-1)
        phi_k = torch.concatenate([_softmax(pk, axis=-1), _softmax(-pk, axis=-1)], axis=-1)
        kv = torch.einsum("bhsf,bhsd->bhfd", phi_k, v)
        z  = torch.einsum("bhsf->bhf", phi_k)
        num = torch.einsum("bhqf,bhfd->bhqd", phi_q, kv)
        den = torch.einsum("bhqf,bhf->bhq", phi_q, z)[..., None] + 1e-6
        o = num / den
        return (lambda x, *d: x.permute(*d))(o, 0, 2, 1, 3).reshape(B, S, D) @ wo

    def _B_ref(x, wq, wk, wv, wo):
        B, S, D = x.shape
        H = 16
        Dh = D // H
        q = (lambda x, *d: x.permute(*d))((x @ wq).reshape(B, S, H, Dh), 0, 2, 1, 3)
        k = x @ wk
        v = x @ wv
        scores = torch.einsum("bhqd,bkd->bhqk", q, k) * (Dh ** -0.5)
        p = _softmax(scores, axis=-1)
        o = torch.einsum("bhqk,bkd->bhqd", p, v)
        return (lambda x, *d: x.permute(*d))(o, 0, 2, 1, 3).reshape(B, S, H * Dh) @ wo

    x = A_x
    g = _sigmoid((x * gate_w).sum(-1, keepdims=True))
    a = _A_ref(x, A_wqkv, A_w_phi, A_wo)
    b = _B_ref(x, B_wq, B_wk, B_wv, B_wo)
    return g * a + (1 - g) * b
```

```asm
; @launch grid=(256,1,1) block=(512,1,1) lds=163840
.amdgcn_target "amdgcn-amd-amdhsa--gfx950"
.text
.globl gated_mix__linear_kernel_hedgehog__grouped_kv_mqa__prompt_kernel
.p2align 8
.type gated_mix__linear_kernel_hedgehog__grouped_kv_mqa__prompt_kernel,@function
gated_mix__linear_kernel_hedgehog__grouped_kv_mqa__prompt_kernel:
    s_load_dwordx16 s[16:31], s[0:1], 0
    s_load_dwordx8 s[32:39], s[0:1], 64
    s_load_dwordx2 s[40:41], s[0:1], 96
    s_cmp_ge_u32 s2, 256
    s_cbranch_scc1 L_end
    v_lshrrev_b32 v2, 6, v0
    v_and_b32 v1, 63, v0
    v_readfirstlane_b32 s3, v2
    v_mov_b32 v242, 162688
    v_mov_b32 v18, 0
    v_mov_b32 v17, 0
    v_lshl_add_u32 v10, v0, 2, v242
    v_cmp_gt_u32 vcc, 32, v0
    s_nop 0
    s_and_saveexec_b64 s[8:9], vcc
    ds_write_b32 v10, v18
    s_mov_b64 exec, -1
    v_lshrrev_b32 v6, 4, v1
    v_and_b32 v8, 15, v1
    s_and_b32 s7, s3, 3
    s_mov_b32 s55, 0x00020000
    s_mov_b32 s79, 0
    s_cmp_ge_u32 s3, 4
    s_cbranch_scc1 L_norp1
    s_lshr_b32 s66, s2, 3
    s_add_u32 s67, s7, 2
    s_and_b32 s67, s67, 3
    s_and_b32 s68, s2, 6
    s_lshl_b32 s68, s68, 1
    s_and_b32 s69, s2, 1
    s_cmp_eq_u32 s67, 3
    s_cselect_b32 s15, 1, 3
    s_cselect_b32 s10, 0, s67
    s_mul_i32 s54, s15, 401408
    s_mul_i32 s15, s15, 896
    s_mul_i32 s10, s10, 896
    s_lshl_b32 s56, s66, 1
    s_add_u32 s56, s56, s69
    s_lshl_b32 s78, s56, 4
    s_lshl_b32 s56, s56, 3
    s_mul_i32 s56, s56, s15
    s_add_u32 s56, s56, s10
    s_mul_i32 s10, s68, 56
    s_add_u32 s56, s56, s10
    s_lshl_b32 s57, s7, 11
    s_add_u32 s57, s57, 152576
    v_min_u32 v7, 13, v8
    v_mul_lo_u32 v5, v6, s15
    v_lshl_add_u32 v5, v7, 4, v5
    s_mov_b32 m0, s57
    s_lshl_b32 s10, s15, 2
    s_cmp_ge_u32 s2, 224
    s_cbranch_scc1 L_norp1
    s_mov_b32 s79, 4
    s_cmp_eq_u32 s67, 3
    s_waitcnt lgkmcnt(0)
    s_load_dwordx2 s[42:43], s[40:41], 389120
    s_load_dwordx4 s[72:75], s[34:35], s78
    s_cselect_b32 s52, s26, s18
    s_cselect_b32 s53, s27, s19
    buffer_load_dwordx4 v5, s[52:55], s56 offen lds
    s_add_u32 m0, s57, 1024
    s_add_u32 s56, s56, s10
    buffer_load_dwordx4 v5, s[52:55], s56 offen lds
L_norp1:
    s_and_b32 s8, s2, 7
    s_lshr_b32 s9, s2, 3
    s_lshr_b32 s4, s8, 1
    s_lshl_b32 s4, s4, 2
    s_and_b32 s10, s9, 3
    s_add_u32 s4, s4, s10
    s_and_b32 s5, s8, 1
    s_lshl_b32 s5, s5, 3
    s_lshr_b32 s58, s9, 2
    s_add_u32 s5, s5, s58
    s_lshr_b32 s6, s5, 1
    s_lshl_b32 s10, s10, 1
    s_add_u32 s58, s58, s10
    s_sub_u32 s8, s58, 7
    s_cmp_ge_u32 s58, 7
    s_cselect_b32 s58, s8, s58
    s_lshr_b32 s13, s3, 2
    s_sub_u32 s13, s3, s13
    s_add_u32 s59, s58, s13
    s_sub_u32 s8, s59, 7
    s_cmp_ge_u32 s59, 7
    s_cselect_b32 s59, s8, s59
    v_lshlrev_b32 v241, 4, v1
    v_lshrrev_b32 v5, 3, v1
    v_mul_u32_u24 v5, 896, v5
    v_and_b32 v7, 7, v1
    v_xor_b32 v7, v7, v6
    v_lshl_add_u32 v3, v7, 4, v5
    v_xor_b32 v7, 4, v7
    v_lshl_add_u32 v4, v7, 4, v5
    v_add_u32 v4, 7168, v4
    s_mul_i32 s11, s4, 114688
    s_mul_i32 s9, s6, 14336
    s_add_u32 s9, s9, s11
    s_lshl_b32 s10, s59, 7
    s_add_u32 s9, s9, s10
    s_lshl_b32 s77, s13, 14
    s_lshl_b32 s12, s6, 11
    s_add_u32 s77, s77, s12
    s_mul_i32 s14, s59, 3584
    s_add_u32 s76, s14, 114688
    s_mov_b32 s46, 1835008
    s_mov_b32 s47, 0x00020000
    s_mov_b32 s62, 25088
    s_mov_b32 s63, 0x00020000
    s_cmp_lg_u32 s79, 0
    s_cbranch_scc1 L_kok
    s_waitcnt lgkmcnt(0)
    s_load_dwordx2 s[42:43], s[40:41], 389120
L_kok:
    s_mov_b32 s44, s16
    s_mov_b32 s45, s17
    s_cmp_eq_u32 s3, 3
    s_cbranch_scc1 L_w3
    s_bitcmp1_b32 s5, 0
    s_cselect_b32 s60, s30, s28
    s_cselect_b32 s61, s31, s29
    s_mov_b32 m0, s76
    s_nop 0
    buffer_load_dwordx4 v241, s[60:63], s14 offen offset:0 lds
    buffer_load_dwordx4 v241, s[60:63], s14 offen offset:1024 lds
    buffer_load_dwordx4 v241, s[60:63], s14 offen offset:2048 lds
    buffer_load_dwordx4 v241, s[60:63], s14 offen offset:3072 lds
    s_mov_b32 m0, s77
    s_add_u32 s10, s77, 1024
    buffer_load_dwordx4 v3, s[44:47], s9 offen lds
    s_mov_b32 m0, s10
    s_nop 0
    buffer_load_dwordx4 v4, s[44:47], s9 offen lds
    s_branch L_b0
L_w3:
    s_sub_u32 s8, s2, 224
    s_cmp_ge_u32 s8, 16
    s_cbranch_scc1 L_b0
    s_mov_b32 s60, s20
    s_mov_b32 s61, s21
    s_mul_i32 s9, s8, 1568
    s_mov_b32 m0, s57
    s_nop 0
    buffer_load_dwordx4 v241, s[60:63], s9 offen lds
    buffer_load_dwordx4 v241, s[60:63], s9 offen offset:1024 lds
L_b0:
    s_mov_b32 s48, s40
    s_mov_b32 s49, s41
    s_mov_b32 s50, 9437184
    s_mov_b32 s51, 0x00020000
    s_mov_b32 s64, 0
    s_mov_b32 s65, -1
    v_mov_b32 v243, 1
    v_mov_b32 v240, 0xdddddddd
    s_cmp_lt_u32 s3, 4
    s_cbranch_scc1 L_a1
    s_lshl_b32 s8, s7, 1
    s_mul_i32 s66, s8, 14336
    s_add_u32 s66, s66, s11
    s_add_u32 s67, s66, 14336
    s_lshl_b32 s68, s7, 12
    s_add_u32 s69, s68, 2048
    s_cmp_eq_u32 s8, s6
    s_cselect_b32 s66, 0x7f000000, s66
    s_cselect_b32 s68, 149504, s68
    s_cselect_b32 s56, 0, 16384
    s_add_u32 s8, s8, 1
    s_cmp_eq_u32 s8, s6
    s_cselect_b32 s67, 0x7f000000, s67
    s_cselect_b32 s69, 149504, s69
    s_cselect_b32 s57, 0, 16384
    s_mov_b32 s13, s58
    s_barrier
    s_lshl_b32 s10, s13, 7
    s_mov_b32 m0, s68
    s_add_u32 s8, s10, s66
    buffer_load_dwordx4 v3, s[44:47], s8 offen lds
    s_add_u32 m0, s68, 1024
    s_add_u32 s68, s68, s56
    buffer_load_dwordx4 v4, s[44:47], s8 offen lds
    s_mov_b32 m0, s69
    s_add_u32 s8, s10, s67
    buffer_load_dwordx4 v3, s[44:47], s8 offen lds
    s_add_u32 m0, s69, 1024
    s_add_u32 s69, s69, s57
    buffer_load_dwordx4 v4, s[44:47], s8 offen lds
    s_add_u32 s13, s13, 1
    s_cmp_eq_u32 s13, 7
    s_cselect_b32 s13, 0, s13
    s_lshl_b32 s10, s13, 7
    s_mov_b32 m0, s68
    s_add_u32 s8, s10, s66
    buffer_load_dwordx4 v3, s[44:47], s8 offen lds
    s_add_u32 m0, s68, 1024
    s_add_u32 s68, s68, s56
    buffer_load_dwordx4 v4, s[44:47], s8 offen lds
    s_mov_b32 m0, s69
    s_add_u32 s8, s10, s67
    buffer_load_dwordx4 v3, s[44:47], s8 offen lds
    s_add_u32 m0, s69, 1024
    s_add_u32 s69, s69, s57
    buffer_load_dwordx4 v4, s[44:47], s8 offen lds
    s_add_u32 s13, s13, 1
    s_cmp_eq_u32 s13, 7
    s_cselect_b32 s13, 0, s13
    s_lshl_b32 s10, s13, 7
    s_mov_b32 m0, s68
    s_add_u32 s8, s10, s66
    buffer_load_dwordx4 v3, s[44:47], s8 offen lds
    s_add_u32 m0, s68, 1024
    s_add_u32 s68, s68, s56
    buffer_load_dwordx4 v4, s[44:47], s8 offen lds
    s_mov_b32 m0, s69
    s_add_u32 s8, s10, s67
    buffer_load_dwordx4 v3, s[44:47], s8 offen lds
    s_add_u32 m0, s69, 1024
    s_add_u32 s69, s69, s57
    buffer_load_dwordx4 v4, s[44:47], s8 offen lds
    s_add_u32 s13, s13, 1
    s_cmp_eq_u32 s13, 7
    s_cselect_b32 s13, 0, s13
    v_lshrrev_b32 v9, 4, v1
    v_lshrrev_b32 v10, 1, v8
    v_xor_b32 v10, v10, v9
    v_lshl_add_u32 v11, v8, 7, s77
    v_lshl_add_u32 v12, v10, 4, v11
    v_xor_b32 v13, 64, v12
    v_lshrrev_b32 v10, 2, v8
    v_lshl_add_u32 v10, v9, 3, v10
    v_mul_u32_u24 v10, 56, v10
    v_and_b32 v11, 3, v1
    v_lshl_add_u32 v14, v11, 3, v10
    v_add_u32 v14, s76, v14
    v_add_u32 v15, s76, v241
    s_waitcnt lgkmcnt(0)
    s_add_u32 s42, s42, 0x7f4a7c15
    s_addc_u32 s43, s43, 0x9e3779b9
    v_mov_b32 v248, s42
    v_mov_b32 v249, s43
    s_lshl_b32 s39, s42, 16
    s_and_b32 s39, s39, 0x9fff0000
    s_or_b32 s39, s39, 0x20000000
    v_mov_b32 v246, 0
    s_waitcnt vmcnt(12)
    s_branch L_mini
L_a1:
    s_setprio 3
    v_lshrrev_b32 v9, 4, v1
    v_lshrrev_b32 v10, 1, v8
    v_xor_b32 v10, v10, v9
    v_lshl_add_u32 v11, v8, 7, s77
    v_lshl_add_u32 v12, v10, 4, v11
    v_xor_b32 v13, 64, v12
    v_lshrrev_b32 v10, 2, v8
    v_lshl_add_u32 v10, v9, 3, v10
    v_mul_u32_u24 v10, 56, v10
    v_and_b32 v11, 3, v1
    v_lshl_add_u32 v14, v11, 3, v10
    v_add_u32 v14, s76, v14
    v_add_u32 v15, s76, v241
    v_and_b32 v20, 31, v1
    v_lshrrev_b32 v21, 5, v1
    v_mul_u32_u24 v22, 37, v20
    v_lshrrev_b32 v22, 8, v22
    v_mul_u32_u24 v23, 7, v22
    v_sub_u32 v23, v20, v23
    v_cmp_eq_u32 vcc, 4, v22
    s_nop 1
    v_cndmask_b32 v22, v22, v23, vcc
    v_cndmask_b32 v23, v23, 7, vcc
    v_and_b32 v18, 4, v23
    v_add_u32 v18, v18, v23
    v_and_b32 v23, 1, v22
    v_lshl_add_u32 v18, v23, 2, v18
    v_lshrrev_b32 v22, 1, v22
    v_lshl_add_u32 v18, v22, 4, v18
    v_lshrrev_b32 v22, 2, v8
    v_and_b32 v23, 3, v1
    v_lshlrev_b32 v23, 3, v23
    v_and_b32 v24, 16, v1
    v_lshl_add_u32 v23, v24, 1, v23
    v_add_u32 v23, s57, v23
    v_lshl_add_u32 v16, v22, 8, v23
    v_mul_u32_u24 v25, 56, v21
    v_add_u32 v16, v16, v25
    v_lshl_add_u32 v22, v21, 2, v22
    v_mul_u32_u24 v22, 56, v22
    v_add_u32 v26, v22, v23
    s_cmp_eq_u32 s67, 2
    s_cselect_b64 vcc, -1, 0
    v_cndmask_b32 v17, v20, v18, vcc
    v_lshlrev_b32 v17, 4, v17
    v_mul_u32_u24 v25, 28672, v21
    v_add_u32 v17, v17, v25
    s_lshl_b32 s56, s67, 4
    s_add_u32 s56, s56, s68
    s_mul_i32 s56, s56, 28
    s_add_u32 s56, s56, s66
    s_lshl_b32 s56, s56, 1
    s_add_u32 s56, s56, s69
    s_lshl_b32 s56, s56, 9
    s_add_u32 s56, s56, 1048576
    s_add_u32 s57, s56, 57344
    s_and_b32 s8, s66, 3
    s_add_u32 s8, s8, s68
    s_lshl_b32 s8, s8, 2
    s_add_u32 s8, s8, s67
    s_lshl_b32 s8, s8, 3
    s_lshr_b32 s9, s66, 2
    s_add_u32 s8, s8, s9
    s_lshl_b32 s8, s8, 1
    s_add_u32 s8, s8, s69
    s_lshl_b32 s78, s8, 4
    s_add_u32 s78, s78, 786432
    s_cmp_eq_u32 s67, 0
    s_cselect_b32 s66, 0x10000000, 0
    s_mov_b32 s67, s66
    s_mov_b32 s68, 0xf0000000
    s_mov_b32 s69, 0xf0000000
    v_lshl_add_u32 v18, v21, 5, v18
    v_lshlrev_b32 v27, 4, v18
    s_barrier
    s_waitcnt lgkmcnt(0)
    s_add_u32 s42, s42, 0x7f4a7c15
    s_addc_u32 s43, s43, 0x9e3779b9
    v_mov_b32 v248, s42
    v_mov_b32 v249, s43
    s_lshl_b32 s39, s42, 16
    s_and_b32 s39, s39, 0x9fff0000
    s_or_b32 s39, s39, 0x20000000
    v_mov_b32 v246, 0
    s_bitcmp0_b32 s3, 0
    s_cbranch_scc1 L_mini0
    s_cmp_eq_u32 s79, 0
    s_cbranch_scc1 L_phi0
    s_cmp_lg_u32 s3, 3
    s_cbranch_scc1 L_rw6
    s_waitcnt vmcnt(0)
L_rw6:
    s_waitcnt vmcnt(6)
    ds_read_b64_tr_b16 v[32:33], v16 offset:0
    ds_read_b64_tr_b16 v[34:35], v16 offset:1024
    ds_read_b64_tr_b16 v[36:37], v16 offset:112
    ds_read_b64_tr_b16 v[38:39], v16 offset:1136
    v_mov_b32 v28, s72
    v_mov_b32 v29, s73
    v_mov_b32 v30, s74
    v_mov_b32 v31, s75
    v_cndmask_b32 v28, 0, v28, s[66:67]
    v_cndmask_b32 v29, 0, v29, s[66:67]
    v_cndmask_b32 v30, 0, v30, s[66:67]
    v_cndmask_b32 v31, 0, v31, s[66:67]
    s_waitcnt lgkmcnt(2)
    v_cndmask_b32 v32, v32, v28, s[68:69]
    v_cndmask_b32 v33, v33, v29, s[68:69]
    v_cndmask_b32 v34, v34, v30, s[68:69]
    v_cndmask_b32 v35, v35, v31, s[68:69]
    buffer_store_dwordx4 v[32:35], v17, s[48:51], s56 offen sc1
    s_waitcnt lgkmcnt(0)
    v_cndmask_b32 v36, v36, v28, s[68:69]
    v_cndmask_b32 v37, v37, v29, s[68:69]
    v_cndmask_b32 v38, v38, v30, s[68:69]
    v_cndmask_b32 v39, v39, v31, s[68:69]
    buffer_store_dwordx4 v[36:39], v17, s[48:51], s57 offen sc1
    s_cmp_eq_u32 s3, 3
    s_cbranch_scc1 L_red
    s_waitcnt vmcnt(2)
    s_branch L_mini
L_phi0:
    s_cmp_eq_u32 s3, 3
    s_cbranch_scc1 L_phi
L_mini0:
    s_waitcnt vmcnt(0)
L_mini:
    ds_read_b128 v[112:115], v12
    ds_read_b64_tr_b16 v[120:121], v14 offset:0
    ds_read_b64_tr_b16 v[122:123], v14 offset:224
    ds_read_b64_tr_b16 v[124:125], v14 offset:32
    ds_read_b64_tr_b16 v[126:127], v14 offset:256
    ds_read_b128 v[116:119], v13
    ds_read_b64_tr_b16 v[128:129], v14 offset:1792
    ds_read_b64_tr_b16 v[130:131], v14 offset:2016
    ds_read_b64_tr_b16 v[132:133], v14 offset:1824
    ds_read_b64_tr_b16 v[134:135], v14 offset:2048
    s_bitcmp1_b32 s5, 0
    s_cbranch_scc1 L_mv
    s_waitcnt lgkmcnt(5)
    v_mfma_f32_16x16x32_bf16 v[136:139], v[120:123], v[112:115], 0
    v_mfma_f32_16x16x32_bf16 v[140:143], v[124:127], v[112:115], 0
    s_waitcnt lgkmcnt(0)
    v_mfma_f32_16x16x32_bf16 v[136:139], v[128:131], v[116:119], v[136:139]
    v_mfma_f32_16x16x32_bf16 v[140:143], v[132:135], v[116:119], v[140:143]
    s_branch L_mw
L_mv:
    s_waitcnt lgkmcnt(5)
    v_mfma_f32_16x16x32_bf16 v[136:139], v[112:115], v[120:123], 0
    v_mfma_f32_16x16x32_bf16 v[140:143], v[112:115], v[124:127], 0
    s_waitcnt lgkmcnt(0)
    v_mfma_f32_16x16x32_bf16 v[136:139], v[116:119], v[128:131], v[136:139]
    v_mfma_f32_16x16x32_bf16 v[140:143], v[116:119], v[132:135], v[140:143]
L_mw:
    s_nop 7
    ds_write_b128 v15, v[136:139] offset:1024
    ds_write_b128 v15, v[140:143] offset:2048
    s_mov_b64 exec, 1
    ds_add_u32 v242, v243 offset:36
    s_mov_b64 exec, -1
    s_cmp_ge_u32 s3, 4
    s_cbranch_scc1 L_helper
    s_cmp_eq_u32 s79, 0
    s_cbranch_scc1 L_attn0
    s_cmp_eq_u32 s3, 1
    s_cbranch_scc1 L_rpack
    ds_read_b64_tr_b16 v[32:33], v16 offset:0
    ds_read_b64_tr_b16 v[34:35], v16 offset:1024
    ds_read_b64_tr_b16 v[36:37], v16 offset:112
    ds_read_b64_tr_b16 v[38:39], v16 offset:1136
    v_mov_b32 v28, s72
    v_mov_b32 v29, s73
    v_mov_b32 v30, s74
    v_mov_b32 v31, s75
    v_cndmask_b32 v28, 0, v28, s[66:67]
    v_cndmask_b32 v29, 0, v29, s[66:67]
    v_cndmask_b32 v30, 0, v30, s[66:67]
    v_cndmask_b32 v31, 0, v31, s[66:67]
    s_waitcnt lgkmcnt(2)
    v_cndmask_b32 v32, v32, v28, s[68:69]
    v_cndmask_b32 v33, v33, v29, s[68:69]
    v_cndmask_b32 v34, v34, v30, s[68:69]
    v_cndmask_b32 v35, v35, v31, s[68:69]
    buffer_store_dwordx4 v[32:35], v17, s[48:51], s56 offen sc1
    s_waitcnt lgkmcnt(0)
    v_cndmask_b32 v36, v36, v28, s[68:69]
    v_cndmask_b32 v37, v37, v29, s[68:69]
    v_cndmask_b32 v38, v38, v30, s[68:69]
    v_cndmask_b32 v39, v39, v31, s[68:69]
    buffer_store_dwordx4 v[36:39], v17, s[48:51], s57 offen sc1
L_rpack:
    s_waitcnt vmcnt(0)
    s_mov_b64 exec, 1
    buffer_store_dwordx2 v[248:249], v246, s[48:51], s78 offen sc1
    s_mov_b64 exec, -1
    s_branch L_attn0
L_phi:
    s_sub_u32 s8, s2, 224
    s_cmp_ge_u32 s8, 16
    s_cbranch_scc1 L_red
    s_lshl_b32 s56, s8, 11
    s_add_u32 s56, s56, 2883584
    s_add_u32 s78, s8, 1024
    s_lshl_b32 s78, s78, 4
    s_add_u32 s78, s78, 786432
    s_mov_b32 s66, 0xf0000000
    s_mov_b32 s67, -1
    s_waitcnt vmcnt(0)
    ds_read_b64_tr_b16 v[32:33], v26 offset:0
    ds_read_b64_tr_b16 v[34:35], v26 offset:448
    ds_read_b64_tr_b16 v[36:37], v26 offset:896
    ds_read_b64_tr_b16 v[38:39], v26 offset:1344
    s_waitcnt lgkmcnt(0)
    v_cndmask_b32 v32, v32, 0, s[68:69]
    v_cndmask_b32 v33, v33, 0, s[68:69]
    v_cndmask_b32 v34, v34, 0, s[68:69]
    v_cndmask_b32 v35, v35, 0, s[68:69]
    v_cndmask_b32 v36, v36, 0, s[68:69]
    v_cndmask_b32 v37, v37, 0, s[68:69]
    v_cndmask_b32 v38, v38, 0, s[66:67]
    v_cndmask_b32 v39, v39, 0, s[66:67]
    buffer_store_dwordx4 v[32:35], v27, s[48:51], s56 offen sc1
    buffer_store_dwordx4 v[36:39], v27, s[48:51], s56 offen offset:1024 sc1
    s_mov_b32 s79, 4
L_red:
    v_add_u32 v15, 115712, v241
    s_lshl_b32 s72, s4, 2
    s_lshr_b32 s9, s6, 1
    s_add_u32 s72, s72, s9
    s_lshl_b32 s72, s72, 12
    s_add_u32 s72, s72, 393216
    s_lshl_b32 s73, s4, 4
    s_add_u32 s73, s73, s5
    s_lshl_b32 s73, s73, 4
    s_and_b32 s9, s6, 1
    s_lshl_b32 s10, s9, 10
    s_addk_i32 s10, 2048
    v_add_u32 v18, s10, v27
    v_lshlrev_b32 v19, 10, v21
    v_lshl_add_u32 v19, v24, 5, v19
    v_lshl_add_u32 v19, v8, 4, v19
    s_lshl_b32 s10, s9, 8
    v_add_u32 v19, s10, v19
    s_bitcmp1_b32 s5, 0
    s_cselect_b64 vcc, -1, 0
    v_cndmask_b32 v18, v19, v18, vcc
    v_mov_b32 v42, 0x3f803f80
    v_mov_b32 v43, 0x00003f80
    s_cmp_eq_u32 s79, 0
    s_cbranch_scc1 L_red2
    s_waitcnt vmcnt(0)
    s_mov_b64 exec, 1
    buffer_store_dwordx2 v[248:249], v246, s[48:51], s78 offen sc1
    s_mov_b64 exec, -1
L_red2:
    s_mov_b32 s70, 0
L_lw_1:
    ds_read_b32 v244, v242 offset:36
    s_waitcnt lgkmcnt(0)
    v_readfirstlane_b32 s71, v244
    s_nop 0
    s_cmp_ge_u32 s71, 7
    s_cbranch_scc1 L_lwd_2
    s_add_u32 s70, s70, 1
    s_cmp_lt_u32 s70, 800000
    s_cbranch_scc1 L_lw_1
L_lwd_2:
    ds_read_b128 v[112:115], v15 offset:0
    ds_read_b128 v[116:119], v15 offset:1024
    ds_read_b128 v[120:123], v15 offset:3584
    ds_read_b128 v[124:127], v15 offset:4608
    ds_read_b128 v[128:131], v15 offset:7168
    ds_read_b128 v[132:135], v15 offset:8192
    ds_read_b128 v[136:139], v15 offset:10752
    ds_read_b128 v[140:143], v15 offset:11776
    ds_read_b128 v[144:147], v15 offset:14336
    ds_read_b128 v[148:151], v15 offset:15360
    ds_read_b128 v[152:155], v15 offset:17920
    ds_read_b128 v[156:159], v15 offset:18944
    ds_read_b128 v[160:163], v15 offset:21504
    ds_read_b128 v[164:167], v15 offset:22528
    s_mov_b64 exec, 1
    ds_add_u32 v242, v243 offset:44
    s_mov_b64 exec, -1
    s_waitcnt lgkmcnt(11)
    v_pk_add_f32 v[112:113], v[112:113], v[120:121]
    v_pk_add_f32 v[114:115], v[114:115], v[122:123]
    v_pk_add_f32 v[116:117], v[116:117], v[124:125]
    v_pk_add_f32 v[118:119], v[118:119], v[126:127]
    s_waitcnt lgkmcnt(9)
    v_pk_add_f32 v[112:113], v[112:113], v[128:129]
    v_pk_add_f32 v[114:115], v[114:115], v[130:131]
    v_pk_add_f32 v[116:117], v[116:117], v[132:133]
    v_pk_add_f32 v[118:119], v[118:119], v[134:135]
    s_waitcnt lgkmcnt(7)
    v_pk_add_f32 v[112:113], v[112:113], v[136:137]
    v_pk_add_f32 v[114:115], v[114:115], v[138:139]
    v_pk_add_f32 v[116:117], v[116:117], v[140:141]
    v_pk_add_f32 v[118:119], v[118:119], v[142:143]
    s_waitcnt lgkmcnt(5)
    v_pk_add_f32 v[112:113], v[112:113], v[144:145]
    v_pk_add_f32 v[114:115], v[114:115], v[146:147]
    v_pk_add_f32 v[116:117], v[116:117], v[148:149]
    v_pk_add_f32 v[118:119], v[118:119], v[150:151]
    s_waitcnt lgkmcnt(3)
    v_pk_add_f32 v[112:113], v[112:113], v[152:153]
    v_pk_add_f32 v[114:115], v[114:115], v[154:155]
    v_pk_add_f32 v[116:117], v[116:117], v[156:157]
    v_pk_add_f32 v[118:119], v[118:119], v[158:159]
    s_waitcnt lgkmcnt(1)
    v_pk_add_f32 v[112:113], v[112:113], v[160:161]
    v_pk_add_f32 v[114:115], v[114:115], v[162:163]
    v_pk_add_f32 v[116:117], v[116:117], v[164:165]
    v_pk_add_f32 v[118:119], v[118:119], v[166:167]
    s_bitcmp1_b32 s5, 0
    s_cselect_b32 s8, 1.0, 0x3e8b97f6
    v_mul_f32 v112, s8, v112
    v_mul_f32 v113, s8, v113
    v_mul_f32 v114, s8, v114
    v_mul_f32 v115, s8, v115
    v_mul_f32 v116, s8, v116
    v_mul_f32 v117, s8, v117
    v_mul_f32 v118, s8, v118
    v_mul_f32 v119, s8, v119
    v_cvt_pk_bf16_f32 v32, v112, v113
    v_cvt_pk_bf16_f32 v33, v114, v115
    v_cvt_pk_bf16_f32 v34, v116, v117
    v_cvt_pk_bf16_f32 v35, v118, v119
    s_bitcmp1_b32 s5, 0
    s_cbranch_scc1 L_red_v
    s_mov_b32 s66, 0
    s_mov_b32 s67, 0xffff0000
    v_permlane32_swap_b32 v32, v34
    v_permlane32_swap_b32 v33, v35
    v_cndmask_b32 v36, v34, 0, s[66:67]
    v_cndmask_b32 v37, v35, 0, s[66:67]
    v_cndmask_b32 v34, v34, v42, s[66:67]
    v_cndmask_b32 v35, v35, v43, s[66:67]
    buffer_store_dwordx4 v[32:35], v18, s[48:51], s72 offen sc1
    v_mov_b32 v40, 0
    v_dot2_f32_bf16 v40, v32, v32, v40
    v_dot2_f32_bf16 v40, v33, v33, v40
    v_dot2_f32_bf16 v40, v36, v36, v40
    v_dot2_f32_bf16 v40, v37, v37, v40
    s_nop 2
    v_mov_b32 v41, v40
    s_nop 1
    v_permlane16_swap_b32 v40, v41
    v_add_f32 v40, v40, v41
    v_mov_b32 v41, v40
    s_nop 1
    v_permlane32_swap_b32 v40, v41
    v_add_f32 v40, v40, v41
    s_nop 1
    v_max_u32_dpp v40, v40, v40 row_ror:8 row_mask:0xf bank_mask:0xf
    s_nop 1
    v_max_u32_dpp v40, v40, v40 row_ror:4 row_mask:0xf bank_mask:0xf
    s_nop 1
    v_max_u32_dpp v40, v40, v40 row_ror:2 row_mask:0xf bank_mask:0xf
    s_nop 1
    v_max_u32_dpp v250, v40, v40 row_ror:1 row_mask:0xf bank_mask:0xf
    s_branch L_pub
L_red_v:
    s_mov_b32 s66, 0x30000000
    s_mov_b32 s67, 0x30000000
    s_mov_b32 s68, 0xc0000000
    s_mov_b32 s69, 0xc0000000
    v_permlane16_swap_b32 v32, v34
    v_permlane16_swap_b32 v33, v35
    v_cndmask_b32 v32, v32, v42, s[66:67]
    v_cndmask_b32 v33, v33, v42, s[66:67]
    v_cndmask_b32 v34, v34, v42, s[66:67]
    v_cndmask_b32 v35, v35, v42, s[66:67]
    v_cndmask_b32 v32, v32, 0, s[68:69]
    v_cndmask_b32 v33, v33, 0, s[68:69]
    v_cndmask_b32 v34, v34, 0, s[68:69]
    v_cndmask_b32 v35, v35, 0, s[68:69]
    buffer_store_dwordx4 v[32:35], v18, s[48:51], s72 offen sc1
    v_mov_b32 v250, 0
L_pub:
L_attn0:
    s_setprio 0
    v_and_b32 v8, 31, v1
    v_lshlrev_b32 v3, 4, v1
    s_lshl_b32 s78, s7, 10
    s_andn2_b32 s9, s5, 3
    s_add_u32 s9, s9, s7
    s_lshl_b32 s9, s9, 6
    v_add_u32 v10, s9, v1
    s_add_u32 s9, s5, 1024
    v_mov_b32 v11, s9
    v_cmp_eq_u32 vcc, 15, v1
    s_nop 1
    v_cndmask_b32 v10, v10, v11, vcc
    v_lshlrev_b32 v2, 4, v10
    s_mov_b32 s79, 786432
    s_mov_b32 s66, 0x3fff8000
    s_mov_b32 s67, 0x3fff0000
    s_mov_b32 s68, 0x00003fff
    s_mov_b32 s69, 0x00003fff
    s_add_u32 s8, s7, 0
    s_and_b32 s8, s8, 3
    s_lshl_b32 s9, s8, 11
    s_add_u32 s9, s9, 152576
    v_add_u32 v4, s9, v241
    s_add_u32 s8, s7, 1
    s_and_b32 s8, s8, 3
    s_lshl_b32 s9, s8, 11
    s_add_u32 s9, s9, 152576
    v_add_u32 v5, s9, v241
    s_add_u32 s8, s7, 2
    s_and_b32 s8, s8, 3
    s_lshl_b32 s9, s8, 11
    s_add_u32 s9, s9, 152576
    v_add_u32 v6, s9, v241
    s_add_u32 s8, s7, 3
    s_and_b32 s8, s8, 3
    s_lshl_b32 s9, s8, 11
    s_add_u32 s9, s9, 152576
    v_add_u32 v7, s9, v241
    s_lshl_b32 s8, s7, 16
    s_add_u32 s8, s8, 393216
    s_add_u32 s52, s40, s8
    s_addc_u32 s53, s41, 0
    s_mov_b32 s54, 65536
    s_mov_b32 s55, 0x00020000
    s_mov_b32 s74, 0
    s_cmp_lg_u32 s3, 3
    s_cbranch_scc1 L_gw
    s_waitcnt vmcnt(0)
    s_mov_b64 exec, 1
    ds_add_u32 v242, v243 offset:56
    s_mov_b64 exec, -1
    s_branch L_gd
L_gw:
    s_mov_b32 s70, 0
L_lw_3:
    ds_read_b32 v244, v242 offset:56
    s_waitcnt lgkmcnt(0)
    v_readfirstlane_b32 s71, v244
    s_nop 0
    s_cmp_ge_u32 s71, 1
    s_cbranch_scc1 L_lwd_4
    s_add_u32 s70, s70, 1
    s_cmp_lt_u32 s70, 800000
    s_cbranch_scc1 L_lw_3
L_lwd_4:
L_gd:
    s_mov_b32 s70, 0
    s_mov_b64 exec, s[66:67]
L_poll_5:
    buffer_load_dwordx2 v[254:255], v2, s[48:51], s79 offen sc1
L_pollc_6:
    s_waitcnt vmcnt(0)
    v_cmp_ne_u64 vcc, s[42:43], v[254:255]
    s_nop 0
    s_cbranch_vccz L_polld_7
    s_mov_b64 s[24:25], vcc
    s_ff1_i32_b64 s71, vcc
    s_lshl_b64 exec, 1, s71
L_poll1_8:
    s_sleep 2
    buffer_load_dwordx2 v[254:255], v2, s[48:51], s79 offen sc1
    s_add_u32 s70, s70, 1
    s_cmp_ge_u32 s70, 100000
    s_cbranch_scc1 L_polld_7
    s_waitcnt vmcnt(0)
    v_cmp_ne_u64 vcc, s[42:43], v[254:255]
    s_nop 0
    s_cbranch_vccnz L_poll1_8
    s_andn2_b64 s[24:25], s[24:25], exec
    s_cbranch_scc0 L_polld_7
    s_mov_b64 exec, s[24:25]
    s_branch L_poll_5
L_polld_7:
    s_mov_b64 exec, -1
    s_mov_b64 exec, 1
    ds_add_u32 v242, v243 offset:4
    s_mov_b64 exec, -1
    s_cmp_lg_u32 s3, 3
    s_cbranch_scc1 L_nokf
    s_mov_b64 exec, 1
    buffer_store_dwordx3 v[248:250], v246, s[48:51], s73 offen sc1
    s_mov_b64 exec, -1
L_nokf:
    s_add_u32 s8, s5, 16
    s_mul_i32 s8, s8, 28672
    s_lshl_b32 s9, s7, 10
    s_add_u32 s8, s8, s9
    s_add_u32 s10, s8, 1048576
    s_mov_b32 s13, s58
    s_lshl_b32 s8, s13, 12
    s_add_u32 m0, s9, 114688
    s_add_u32 s14, s8, s10
    buffer_load_dwordx4 v241, s[48:51], s14 offen sc1 lds
    s_add_u32 s13, s13, 1
    s_cmp_eq_u32 s13, 7
    s_cselect_b32 s13, 0, s13
    s_lshl_b32 s8, s13, 12
    s_add_u32 m0, s9, 118784
    s_add_u32 s14, s8, s10
    buffer_load_dwordx4 v241, s[48:51], s14 offen sc1 lds
    s_add_u32 s13, s13, 1
    s_cmp_eq_u32 s13, 7
    s_cselect_b32 s13, 0, s13
    s_lshl_b32 s8, s13, 12
    s_add_u32 m0, s9, 122880
    s_add_u32 s14, s8, s10
    buffer_load_dwordx4 v241, s[48:51], s14 offen sc1 lds
    s_add_u32 s13, s13, 1
    s_cmp_eq_u32 s13, 7
    s_cselect_b32 s13, 0, s13
    s_lshl_b32 s8, s13, 12
    s_add_u32 m0, s9, 126976
    s_add_u32 s14, s8, s10
    buffer_load_dwordx4 v241, s[48:51], s14 offen sc1 lds
    s_add_u32 s13, s13, 1
    s_cmp_eq_u32 s13, 7
    s_cselect_b32 s13, 0, s13
    s_lshl_b32 s8, s13, 12
    s_add_u32 m0, s9, 131072
    s_add_u32 s14, s8, s10
    buffer_load_dwordx4 v241, s[48:51], s14 offen sc1 lds
    s_add_u32 s13, s13, 1
    s_cmp_eq_u32 s13, 7
    s_cselect_b32 s13, 0, s13
    s_lshl_b32 s8, s13, 12
    s_add_u32 m0, s9, 135168
    s_add_u32 s14, s8, s10
    buffer_load_dwordx4 v241, s[48:51], s14 offen sc1 lds
    s_add_u32 s13, s13, 1
    s_cmp_eq_u32 s13, 7
    s_cselect_b32 s13, 0, s13
    s_lshl_b32 s8, s13, 12
    s_add_u32 m0, s9, 139264
    s_add_u32 s14, s8, s10
    buffer_load_dwordx4 v241, s[48:51], s14 offen sc1 lds
    s_add_u32 s13, s13, 1
    s_cmp_eq_u32 s13, 7
    s_cselect_b32 s13, 0, s13
    s_mov_b32 s70, 0
L_lw_9:
    ds_read_b32 v244, v242 offset:52
    s_waitcnt lgkmcnt(0)
    v_readfirstlane_b32 s71, v244
    s_nop 0
    s_cmp_ge_u32 s71, 8
    s_cbranch_scc1 L_lwd_10
    s_add_u32 s70, s70, 1
    s_cmp_lt_u32 s70, 800000
    s_cbranch_scc1 L_lw_9
L_lwd_10:
    s_add_u32 s8, s5, 48
    s_mul_i32 s8, s8, 28672
    s_lshl_b32 s9, s7, 10
    s_add_u32 s8, s8, s9
    s_add_u32 s10, s8, 1048576
    s_mov_b32 s13, s58
    s_waitcnt vmcnt(5)
    s_mov_b64 exec, 1
    ds_add_u32 v242, v243 offset:40
    s_mov_b64 exec, -1
    s_lshl_b32 s8, s13, 12
    s_add_u32 m0, s9, 0
    s_add_u32 s14, s8, s10
    buffer_load_dwordx4 v241, s[48:51], s14 offen sc1 lds
    s_add_u32 s13, s13, 1
    s_cmp_eq_u32 s13, 7
    s_cselect_b32 s13, 0, s13
    s_lshl_b32 s8, s13, 12
    s_add_u32 m0, s9, 4096
    s_add_u32 s14, s8, s10
    buffer_load_dwordx4 v241, s[48:51], s14 offen sc1 lds
    s_add_u32 s13, s13, 1
    s_cmp_eq_u32 s13, 7
    s_cselect_b32 s13, 0, s13
    s_waitcnt vmcnt(2)
    s_mov_b64 exec, 1
    ds_add_u32 v242, v243 offset:28
    s_mov_b64 exec, -1
    s_lshl_b32 s8, s13, 12
    s_add_u32 m0, s9, 8192
    s_add_u32 s14, s8, s10
    buffer_load_dwordx4 v241, s[48:51], s14 offen sc1 lds
    s_add_u32 s13, s13, 1
    s_cmp_eq_u32 s13, 7
    s_cselect_b32 s13, 0, s13
    s_lshl_b32 s8, s13, 12
    s_add_u32 m0, s9, 12288
    s_add_u32 s14, s8, s10
    buffer_load_dwordx4 v241, s[48:51], s14 offen sc1 lds
    s_add_u32 s13, s13, 1
    s_cmp_eq_u32 s13, 7
    s_cselect_b32 s13, 0, s13
    s_lshl_b32 s8, s13, 12
    s_add_u32 m0, s9, 16384
    s_add_u32 s14, s8, s10
    buffer_load_dwordx4 v241, s[48:51], s14 offen sc1 lds
    s_add_u32 s13, s13, 1
    s_cmp_eq_u32 s13, 7
    s_cselect_b32 s13, 0, s13
    s_lshl_b32 s8, s13, 12
    s_add_u32 m0, s9, 20480
    s_add_u32 s14, s8, s10
    buffer_load_dwordx4 v241, s[48:51], s14 offen sc1 lds
    s_add_u32 s13, s13, 1
    s_cmp_eq_u32 s13, 7
    s_cselect_b32 s13, 0, s13
    s_lshl_b32 s8, s13, 12
    s_add_u32 m0, s9, 24576
    s_add_u32 s14, s8, s10
    buffer_load_dwordx4 v241, s[48:51], s14 offen sc1 lds
    s_add_u32 s13, s13, 1
    s_cmp_eq_u32 s13, 7
    s_cselect_b32 s13, 0, s13
    s_mov_b64 exec, s[68:69]
    buffer_load_dwordx2 v[254:255], v2, s[48:51], s79 offen sc1
    s_mov_b64 exec, -1
    s_waitcnt vmcnt(1)
    s_mov_b64 exec, 1
    ds_add_u32 v242, v243 offset:0
    s_mov_b64 exec, -1
    s_mov_b32 s70, 0
    s_mov_b64 exec, s[68:69]
    s_branch L_pollc_12
L_poll_11:
    buffer_load_dwordx2 v[254:255], v2, s[48:51], s79 offen sc1
L_pollc_12:
    s_waitcnt vmcnt(0)
    v_cmp_ne_u64 vcc, s[42:43], v[254:255]
    s_nop 0
    s_cbranch_vccz L_polld_13
    s_mov_b64 s[24:25], vcc
    s_ff1_i32_b64 s71, vcc
    s_lshl_b64 exec, 1, s71
L_poll1_14:
    s_sleep 2
    buffer_load_dwordx2 v[254:255], v2, s[48:51], s79 offen sc1
    s_add_u32 s70, s70, 1
    s_cmp_ge_u32 s70, 100000
    s_cbranch_scc1 L_polld_13
    s_waitcnt vmcnt(0)
    v_cmp_ne_u64 vcc, s[42:43], v[254:255]
    s_nop 0
    s_cbranch_vccnz L_poll1_14
    s_andn2_b64 s[24:25], s[24:25], exec
    s_cbranch_scc0 L_polld_13
    s_mov_b64 exec, s[24:25]
    s_branch L_poll_11
L_polld_13:
    s_mov_b64 exec, -1
    s_add_u32 s8, s5, 32
    s_mul_i32 s8, s8, 28672
    s_lshl_b32 s9, s7, 10
    s_add_u32 s8, s8, s9
    s_add_u32 s10, s8, 1048576
    s_mov_b32 s13, s58
    s_lshl_b32 s8, s13, 12
    s_add_u32 m0, s9, 28672
    s_add_u32 s14, s8, s10
    buffer_load_dwordx4 v241, s[48:51], s14 offen sc1 lds
    s_add_u32 s13, s13, 1
    s_cmp_eq_u32 s13, 7
    s_cselect_b32 s13, 0, s13
    s_lshl_b32 s8, s13, 12
    s_add_u32 m0, s9, 32768
    s_add_u32 s14, s8, s10
    buffer_load_dwordx4 v241, s[48:51], s14 offen sc1 lds
    s_add_u32 s13, s13, 1
    s_cmp_eq_u32 s13, 7
    s_cselect_b32 s13, 0, s13
    s_lshl_b32 s8, s13, 12
    s_add_u32 m0, s9, 36864
    s_add_u32 s14, s8, s10
    buffer_load_dwordx4 v241, s[48:51], s14 offen sc1 lds
    s_add_u32 s13, s13, 1
    s_cmp_eq_u32 s13, 7
    s_cselect_b32 s13, 0, s13
    s_lshl_b32 s8, s13, 12
    s_add_u32 m0, s9, 40960
    s_add_u32 s14, s8, s10
    buffer_load_dwordx4 v241, s[48:51], s14 offen sc1 lds
    s_add_u32 s13, s13, 1
    s_cmp_eq_u32 s13, 7
    s_cselect_b32 s13, 0, s13
    s_lshl_b32 s8, s13, 12
    s_add_u32 m0, s9, 45056
    s_add_u32 s14, s8, s10
    buffer_load_dwordx4 v241, s[48:51], s14 offen sc1 lds
    s_add_u32 s13, s13, 1
    s_cmp_eq_u32 s13, 7
    s_cselect_b32 s13, 0, s13
    s_lshl_b32 s8, s13, 12
    s_add_u32 m0, s9, 49152
    s_add_u32 s14, s8, s10
    buffer_load_dwordx4 v241, s[48:51], s14 offen sc1 lds
    s_add_u32 s13, s13, 1
    s_cmp_eq_u32 s13, 7
    s_cselect_b32 s13, 0, s13
    s_lshl_b32 s8, s13, 12
    s_add_u32 m0, s9, 53248
    s_add_u32 s14, s8, s10
    buffer_load_dwordx4 v241, s[48:51], s14 offen sc1 lds
    s_add_u32 s13, s13, 1
    s_cmp_eq_u32 s13, 7
    s_cselect_b32 s13, 0, s13
    s_add_u32 s8, s5, 0
    s_mul_i32 s8, s8, 28672
    s_lshl_b32 s9, s7, 10
    s_add_u32 s8, s8, s9
    s_add_u32 s10, s8, 1048576
    s_mov_b32 s13, s58
    s_lshl_b32 s8, s13, 12
    s_add_u32 m0, s9, 57344
    s_add_u32 s14, s8, s10
    buffer_load_dwordx4 v241, s[48:51], s14 offen sc1 lds
    s_add_u32 s13, s13, 1
    s_cmp_eq_u32 s13, 7
    s_cselect_b32 s13, 0, s13
    s_lshl_b32 s8, s13, 12
    s_add_u32 m0, s9, 61440
    s_add_u32 s14, s8, s10
    buffer_load_dwordx4 v241, s[48:51], s14 offen sc1 lds
    s_add_u32 s13, s13, 1
    s_cmp_eq_u32 s13, 7
    s_cselect_b32 s13, 0, s13
    s_lshl_b32 s8, s13, 12
    s_add_u32 m0, s9, 65536
    s_add_u32 s14, s8, s10
    buffer_load_dwordx4 v241, s[48:51], s14 offen sc1 lds
    s_add_u32 s13, s13, 1
    s_cmp_eq_u32 s13, 7
    s_cselect_b32 s13, 0, s13
    s_lshl_b32 s8, s13, 12
    s_add_u32 m0, s9, 69632
    s_add_u32 s14, s8, s10
    buffer_load_dwordx4 v241, s[48:51], s14 offen sc1 lds
    s_add_u32 s13, s13, 1
    s_cmp_eq_u32 s13, 7
    s_cselect_b32 s13, 0, s13
    s_lshl_b32 s8, s13, 12
    s_add_u32 m0, s9, 73728
    s_add_u32 s14, s8, s10
    buffer_load_dwordx4 v241, s[48:51], s14 offen sc1 lds
    s_add_u32 s13, s13, 1
    s_cmp_eq_u32 s13, 7
    s_cselect_b32 s13, 0, s13
    s_lshl_b32 s8, s13, 12
    s_add_u32 m0, s9, 77824
    s_add_u32 s14, s8, s10
    buffer_load_dwordx4 v241, s[48:51], s14 offen sc1 lds
    s_add_u32 s13, s13, 1
    s_cmp_eq_u32 s13, 7
    s_cselect_b32 s13, 0, s13
    s_lshl_b32 s8, s13, 12
    s_add_u32 m0, s9, 81920
    s_add_u32 s14, s8, s10
    buffer_load_dwordx4 v241, s[48:51], s14 offen sc1 lds
    s_add_u32 s13, s13, 1
    s_cmp_eq_u32 s13, 7
    s_cselect_b32 s13, 0, s13
    buffer_load_dwordx3 v[250:252], v3, s[48:51], s78 offen sc1
    v_mov_b32 v48, 0
    v_mov_b32 v49, 0
    v_mov_b32 v50, 0
    v_mov_b32 v51, 0
    v_mov_b32 v52, 0
    v_mov_b32 v53, 0
    v_mov_b32 v54, 0
    v_mov_b32 v55, 0
    v_mov_b32 v56, 0
    v_mov_b32 v57, 0
    v_mov_b32 v58, 0
    v_mov_b32 v59, 0
    v_mov_b32 v60, 0
    v_mov_b32 v61, 0
    v_mov_b32 v62, 0
    v_mov_b32 v63, 0
    v_mov_b32 v64, 0
    v_mov_b32 v65, 0
    v_mov_b32 v66, 0
    v_mov_b32 v67, 0
    v_mov_b32 v68, 0
    v_mov_b32 v69, 0
    v_mov_b32 v70, 0
    v_mov_b32 v71, 0
    v_mov_b32 v72, 0
    v_mov_b32 v73, 0
    v_mov_b32 v74, 0
    v_mov_b32 v75, 0
    v_mov_b32 v76, 0
    v_mov_b32 v77, 0
    v_mov_b32 v78, 0
    v_mov_b32 v79, 0
    v_mov_b32 v80, 0
    v_mov_b32 v81, 0
    v_mov_b32 v82, 0
    v_mov_b32 v83, 0
    v_mov_b32 v84, 0
    v_mov_b32 v85, 0
    v_mov_b32 v86, 0
    v_mov_b32 v87, 0
    v_mov_b32 v88, 0
    v_mov_b32 v89, 0
    v_mov_b32 v90, 0
    v_mov_b32 v91, 0
    v_mov_b32 v92, 0
    v_mov_b32 v93, 0
    v_mov_b32 v94, 0
    v_mov_b32 v95, 0
    v_mov_b32 v96, 0
    v_mov_b32 v97, 0
    v_mov_b32 v98, 0
    v_mov_b32 v99, 0
    v_mov_b32 v100, 0
    v_mov_b32 v101, 0
    v_mov_b32 v102, 0
    v_mov_b32 v103, 0
    v_mov_b32 v104, 0
    v_mov_b32 v105, 0
    v_mov_b32 v106, 0
    v_mov_b32 v107, 0
    v_mov_b32 v108, 0
    v_mov_b32 v109, 0
    v_mov_b32 v110, 0
    v_mov_b32 v111, 0
    v_mov_b32 v232, 0
    v_mov_b32 v233, 0
    v_mov_b32 v234, 0
    v_mov_b32 v235, 0
    v_mov_b32 v236, 0
    v_mov_b32 v237, 0
    v_mov_b32 v238, 0
    v_mov_b32 v239, 0
    v_mov_b32 v160, 0
    v_mov_b32 v161, 0
    v_mov_b32 v162, 0
    v_mov_b32 v163, 0
    v_mov_b32 v164, 0
    v_mov_b32 v165, 0
    v_mov_b32 v166, 0
    v_mov_b32 v167, 0
    v_mov_b32 v168, 0
    v_mov_b32 v169, 0
    v_mov_b32 v170, 0
    v_mov_b32 v171, 0
    v_mov_b32 v172, 0
    v_mov_b32 v173, 0
    v_mov_b32 v174, 0
    v_mov_b32 v175, 0
    s_mov_b32 s70, 0
    s_branch L_pollc_16
L_poll_15:
    buffer_load_dwordx3 v[250:252], v3, s[48:51], s78 offen sc1
L_pollc_16:
    s_waitcnt vmcnt(0)
    v_cmp_ne_u64 vcc, s[42:43], v[250:251]
    s_nop 0
    s_cbranch_vccz L_polld_17
    s_mov_b64 s[24:25], vcc
    s_ff1_i32_b64 s71, vcc
    s_lshl_b64 exec, 1, s71
L_poll1_18:
    s_sleep 2
    buffer_load_dwordx3 v[250:252], v3, s[48:51], s78 offen sc1
    s_add_u32 s70, s70, 1
    s_cmp_ge_u32 s70, 100000
    s_cbranch_scc1 L_polld_17
    s_waitcnt vmcnt(0)
    v_cmp_ne_u64 vcc, s[42:43], v[250:251]
    s_nop 0
    s_cbranch_vccnz L_poll1_18
    s_andn2_b64 s[24:25], s[24:25], exec
    s_cbranch_scc0 L_polld_17
    s_mov_b64 exec, s[24:25]
    s_branch L_poll_15
L_polld_17:
    s_mov_b64 exec, -1
    s_mov_b64 exec, 1
    ds_add_u32 v242, v243 offset:48
    s_mov_b64 exec, -1
    v_max_u32_dpp v252, v252, v252 row_ror:8 row_mask:0xf bank_mask:0xf
    s_nop 1
    v_max_u32_dpp v252, v252, v252 row_ror:4 row_mask:0xf bank_mask:0xf
    s_nop 1
    v_max_u32_dpp v252, v252, v252 row_ror:2 row_mask:0xf bank_mask:0xf
    s_mov_b32 s8, 0x00010001
    s_mov_b32 s9, 0x00010001
    s_mov_b64 exec, s[8:9]
    ds_max_u32 v242, v252 offset:20
    s_mov_b64 exec, -1
    s_mov_b64 exec, 1
    ds_add_u32 v242, v243 offset:16
    s_mov_b64 exec, -1
    buffer_load_dwordx4 v[176:179], v241, s[52:55], s74 offen offset:0 sc1
    buffer_load_dwordx4 v[180:183], v241, s[52:55], s74 offen offset:1024 sc1
    buffer_load_dwordx4 v[184:187], v241, s[52:55], s74 offen offset:2048 sc1
    buffer_load_dwordx4 v[188:191], v241, s[52:55], s74 offen offset:3072 sc1
    s_addk_i32 s74, 4096
    buffer_load_dwordx4 v[192:195], v241, s[52:55], s74 offen offset:0 sc1
    buffer_load_dwordx4 v[196:199], v241, s[52:55], s74 offen offset:1024 sc1
    buffer_load_dwordx4 v[200:203], v241, s[52:55], s74 offen offset:2048 sc1
    buffer_load_dwordx4 v[204:207], v241, s[52:55], s74 offen offset:3072 sc1
    s_addk_i32 s74, 4096
    buffer_load_dwordx4 v[208:211], v241, s[52:55], s74 offen offset:0 sc1
    buffer_load_dwordx4 v[212:215], v241, s[52:55], s74 offen offset:1024 sc1
    buffer_load_dwordx4 v[216:219], v241, s[52:55], s74 offen offset:2048 sc1
    buffer_load_dwordx4 v[220:223], v241, s[52:55], s74 offen offset:3072 sc1
    s_addk_i32 s74, 4096
    buffer_load_dwordx4 v[224:227], v241, s[52:55], s74 offen offset:0 sc1
    buffer_load_dwordx4 v[228:231], v241, s[52:55], s74 offen offset:1024 sc1
    s_add_u32 s8, s7, 1
    s_and_b32 s8, s8, 3
    s_mul_i32 s8, s8, 12288
    s_add_u32 s8, s8, 60416
    v_add_u32 v9, s8, v241
    s_add_u32 s8, s7, 2
    s_and_b32 s8, s8, 3
    s_mul_i32 s8, s8, 12288
    s_add_u32 s8, s8, 64512
    v_add_u32 v10, s8, v241
    s_add_u32 s8, s7, 3
    s_and_b32 s8, s8, 3
    s_mul_i32 s8, s8, 12288
    s_add_u32 s8, s8, 68608
    v_add_u32 v11, s8, v241
    s_mul_i32 s8, s7, 12288
    s_add_u32 s8, s8, 60416
    v_add_u32 v12, s8, v241
    s_lshl_b32 s8, s7, 7
    s_add_u32 s8, s8, 163328
    v_lshl_add_u32 v13, v8, 2, s8
    s_lshl_b32 s8, s4, 2
    s_add_u32 s8, s8, s7
    s_lshl_b32 s8, s8, 4
    s_add_u32 s8, s8, s5
    s_lshl_b32 s77, s8, 11
    s_add_u32 s77, s77, 6291456
    s_lshl_b32 s79, s4, 4
    s_lshr_b32 s71, s7, 1
    s_lshl_b32 s71, s71, 3
    s_add_u32 s79, s79, s71
    s_lshl_b32 s79, s79, 2
    s_lshr_b32 s71, s5, 2
    s_add_u32 s79, s79, s71
    s_lshl_b32 s79, s79, 3
    s_and_b32 s71, s7, 1
    s_add_u32 s79, s79, s71
    s_lshl_b32 s79, s79, 2
    s_and_b32 s71, s5, 3
    s_add_u32 s79, s79, s71
    s_lshl_b32 s79, s79, 2
    s_add_u32 s79, s79, 655360
    s_add_u32 s8, s7, 0
    s_and_b32 s8, s8, 3
    s_lshl_b32 s8, s8, 2
    s_add_u32 s8, s8, 162752
    v_mov_b32 v250, s8
    s_add_u32 s8, s7, 1
    s_and_b32 s8, s8, 3
    s_lshl_b32 s8, s8, 2
    s_add_u32 s8, s8, 162752
    v_mov_b32 v251, s8
    s_add_u32 s8, s7, 2
    s_and_b32 s8, s8, 3
    s_lshl_b32 s8, s8, 2
    s_add_u32 s8, s8, 162752
    v_mov_b32 v252, s8
    s_add_u32 s8, s7, 3
    s_and_b32 s8, s8, 3
    s_lshl_b32 s8, s8, 2
    s_add_u32 s8, s8, 162752
    v_mov_b32 v253, s8
    v_mov_b32 v254, 0x100
    s_mov_b32 s75, 0
    v_lshlrev_b32 v2, 5, v241
    s_mov_b32 s70, 0
L_lw_19:
    ds_read_b32 v244, v242 offset:60
    s_waitcnt lgkmcnt(0)
    v_readfirstlane_b32 s71, v244
    s_nop 0
    s_cmp_ge_u32 s71, 4
    s_cbranch_scc1 L_lwd_20
    s_add_u32 s70, s70, 1
    s_cmp_lt_u32 s70, 800000
    s_cbranch_scc1 L_lw_19
L_lwd_20:
    s_setprio 3
    ds_read_b128 v[16:19], v4
    ds_read_b128 v[20:23], v4 offset:1024
    ds_read_b128 v[24:27], v5
    ds_read_b128 v[28:31], v5 offset:1024
    ds_read_b128 v[32:35], v6
    ds_read_b128 v[36:39], v6 offset:1024
    ds_read_b128 v[40:43], v7
    ds_read_b128 v[44:47], v7 offset:1024
    s_waitcnt lgkmcnt(6)
    s_setprio 1
    s_waitcnt vmcnt(10)
    v_mfma_f32_32x32x16_bf16 v[112:127], v[176:179], v[16:19], 0
    v_mfma_f32_32x32x16_bf16 v[112:127], v[180:183], v[20:23], v[112:127]
    s_waitcnt lgkmcnt(0)
    s_nop 7
    s_nop 1
.p2align 3
L_attn:
    v_mfma_f32_32x32x16_bf16 v[128:143], v[176:179], v[24:27], 0
    v_exp_f32 v112, v112
    v_exp_f32 v113, v113
    v_exp_f32_e64 v114, v114
    v_mfma_f32_32x32x16_bf16 v[128:143], v[180:183], v[28:31], v[128:143]
    v_exp_f32 v115, v115
    v_exp_f32 v116, v116
    v_exp_f32_e64 v117, v117
    v_smfmac_f32_32x32x32_bf16 v[96:111], v[232:235], v[160:167], v240
    buffer_load_dwordx4 v[232:235], v241, s[52:55], s74 offen offset:2048 sc1
    v_exp_f32 v118, v118
    v_exp_f32 v119, v119
    v_exp_f32_e64 v120, v120
    v_smfmac_f32_32x32x32_bf16 v[96:111], v[236:239], v[168:175], v240
    buffer_load_dwordx4 v[236:239], v241, s[52:55], s74 offen offset:3072 sc1
    v_exp_f32 v121, v121
    v_exp_f32 v122, v122
    v_exp_f32 v123, v123
    v_exp_f32 v124, v124
    v_exp_f32 v125, v125
    v_exp_f32 v126, v126
    v_exp_f32_e64 v127, v127
    v_mfma_f32_32x32x16_bf16 v[144:159], v[176:179], v[32:35], 0
    s_add_u32 s76, s74, 4096
    v_exp_f32 v128, v128
    v_exp_f32 v129, v129
    v_exp_f32_e64 v130, v130
    v_mfma_f32_32x32x16_bf16 v[144:159], v[180:183], v[36:39], v[144:159]
    v_exp_f32 v131, v131
    v_exp_f32 v132, v132
    v_exp_f32_e64 v133, v133
    v_smfmac_f32_32x32x32_bf16 v[48:63], v[184:187], v[112:119], v240
    v_exp_f32 v134, v134
    v_exp_f32 v135, v135
    v_exp_f32_e64 v136, v136
    v_smfmac_f32_32x32x32_bf16 v[48:63], v[188:191], v[120:127], v240
    v_exp_f32 v137, v137
    v_exp_f32 v138, v138
    v_exp_f32 v139, v139
    v_exp_f32 v140, v140
    v_exp_f32 v141, v141
    v_exp_f32 v142, v142
    v_exp_f32_e64 v143, v143
    v_mfma_f32_32x32x16_bf16 v[160:175], v[176:179], v[40:43], 0
    v_exp_f32 v144, v144
    v_exp_f32 v145, v145
    v_exp_f32_e64 v146, v146
    v_mfma_f32_32x32x16_bf16 v[160:175], v[180:183], v[44:47], v[160:175]
    s_waitcnt vmcnt(8)
    s_addk_i32 s74, 4096
    v_exp_f32 v147, v147
    v_exp_f32 v148, v148
    v_exp_f32_e64 v149, v149
    v_smfmac_f32_32x32x32_bf16 v[64:79], v[184:187], v[128:135], v240
    buffer_load_dwordx4 v[176:179], v241, s[52:55], s76 offen offset:0 sc1
    v_exp_f32 v150, v150
    v_exp_f32 v151, v151
    v_exp_f32_e64 v152, v152
    v_smfmac_f32_32x32x32_bf16 v[64:79], v[188:191], v[136:143], v240
    buffer_load_dwordx4 v[180:183], v241, s[52:55], s76 offen offset:1024 sc1
    v_exp_f32 v153, v153
    v_exp_f32 v154, v154
    v_exp_f32 v155, v155
    v_exp_f32 v156, v156
    v_exp_f32 v157, v157
    v_exp_f32 v158, v158
    v_exp_f32_e64 v159, v159
    v_mfma_f32_32x32x16_bf16 v[112:127], v[192:195], v[16:19], 0
    v_exp_f32 v160, v160
    v_exp_f32 v161, v161
    v_exp_f32_e64 v162, v162
    v_mfma_f32_32x32x16_bf16 v[112:127], v[196:199], v[20:23], v[112:127]
    v_exp_f32 v163, v163
    v_exp_f32 v164, v164
    v_exp_f32_e64 v165, v165
    v_smfmac_f32_32x32x32_bf16 v[80:95], v[184:187], v[144:151], v240
    v_exp_f32 v166, v166
    v_exp_f32 v167, v167
    v_exp_f32_e64 v168, v168
    v_smfmac_f32_32x32x32_bf16 v[80:95], v[188:191], v[152:159], v240
    v_exp_f32 v169, v169
    v_exp_f32 v170, v170
    v_exp_f32 v171, v171
    v_exp_f32 v172, v172
    v_exp_f32 v173, v173
    v_exp_f32 v174, v174
    v_exp_f32_e64 v175, v175
    v_mfma_f32_32x32x16_bf16 v[128:143], v[192:195], v[24:27], 0
    v_exp_f32 v112, v112
    v_exp_f32 v113, v113
    v_exp_f32_e64 v114, v114
    v_mfma_f32_32x32x16_bf16 v[128:143], v[196:199], v[28:31], v[128:143]
    v_exp_f32 v115, v115
    v_exp_f32 v116, v116
    v_exp_f32_e64 v117, v117
    v_smfmac_f32_32x32x32_bf16 v[96:111], v[184:187], v[160:167], v240
    buffer_load_dwordx4 v[184:187], v241, s[52:55], s74 offen offset:2048 sc1
    v_exp_f32 v118, v118
    v_exp_f32 v119, v119
    v_exp_f32_e64 v120, v120
    v_smfmac_f32_32x32x32_bf16 v[96:111], v[188:191], v[168:175], v240
    buffer_load_dwordx4 v[188:191], v241, s[52:55], s74 offen offset:3072 sc1
    v_exp_f32 v121, v121
    v_exp_f32 v122, v122
    v_exp_f32 v123, v123
    v_exp_f32 v124, v124
    v_exp_f32 v125, v125
    v_exp_f32 v126, v126
    v_exp_f32_e64 v127, v127
    v_mfma_f32_32x32x16_bf16 v[144:159], v[192:195], v[32:35], 0
    s_add_u32 s76, s74, 4096
    v_exp_f32 v128, v128
    v_exp_f32 v129, v129
    v_exp_f32_e64 v130, v130
    v_mfma_f32_32x32x16_bf16 v[144:159], v[196:199], v[36:39], v[144:159]
    v_exp_f32 v131, v131
    v_exp_f32 v132, v132
    v_exp_f32_e64 v133, v133
    v_smfmac_f32_32x32x32_bf16 v[48:63], v[200:203], v[112:119], v240
    v_exp_f32 v134, v134
    v_exp_f32 v135, v135
    v_exp_f32_e64 v136, v136
    v_smfmac_f32_32x32x32_bf16 v[48:63], v[204:207], v[120:127], v240
    v_exp_f32 v137, v137
    v_exp_f32 v138, v138
    v_exp_f32 v139, v139
    v_exp_f32 v140, v140
    v_exp_f32 v141, v141
    v_exp_f32 v142, v142
    v_exp_f32_e64 v143, v143
    v_mfma_f32_32x32x16_bf16 v[160:175], v[192:195], v[40:43], 0
    v_exp_f32 v144, v144
    v_exp_f32 v145, v145
    v_exp_f32_e64 v146, v146
    v_mfma_f32_32x32x16_bf16 v[160:175], v[196:199], v[44:47], v[160:175]
    s_waitcnt vmcnt(8)
    s_addk_i32 s74, 4096
    v_exp_f32 v147, v147
    v_exp_f32 v148, v148
    v_exp_f32_e64 v149, v149
    v_smfmac_f32_32x32x32_bf16 v[64:79], v[200:203], v[128:135], v240
    buffer_load_dwordx4 v[192:195], v241, s[52:55], s76 offen offset:0 sc1
    v_exp_f32 v150, v150
    v_exp_f32 v151, v151
    v_exp_f32_e64 v152, v152
    v_smfmac_f32_32x32x32_bf16 v[64:79], v[204:207], v[136:143], v240
    buffer_load_dwordx4 v[196:199], v241, s[52:55], s76 offen offset:1024 sc1
    v_exp_f32 v153, v153
    v_exp_f32 v154, v154
    v_exp_f32 v155, v155
    v_exp_f32 v156, v156
    v_exp_f32 v157, v157
    v_exp_f32 v158, v158
    v_exp_f32_e64 v159, v159
    v_mfma_f32_32x32x16_bf16 v[112:127], v[208:211], v[16:19], 0
    v_exp_f32 v160, v160
    v_exp_f32 v161, v161
    v_exp_f32_e64 v162, v162
    v_mfma_f32_32x32x16_bf16 v[112:127], v[212:215], v[20:23], v[112:127]
    v_exp_f32 v163, v163
    v_exp_f32 v164, v164
    v_exp_f32_e64 v165, v165
    v_smfmac_f32_32x32x32_bf16 v[80:95], v[200:203], v[144:151], v240
    v_exp_f32 v166, v166
    v_exp_f32 v167, v167
    v_exp_f32_e64 v168, v168
    v_smfmac_f32_32x32x32_bf16 v[80:95], v[204:207], v[152:159], v240
    v_exp_f32 v169, v169
    v_exp_f32 v170, v170
    v_exp_f32 v171, v171
    v_exp_f32 v172, v172
    v_exp_f32 v173, v173
    v_exp_f32 v174, v174
    v_exp_f32_e64 v175, v175
    v_mfma_f32_32x32x16_bf16 v[128:143], v[208:211], v[24:27], 0
    v_exp_f32 v112, v112
    v_exp_f32 v113, v113
    v_exp_f32_e64 v114, v114
    v_mfma_f32_32x32x16_bf16 v[128:143], v[212:215], v[28:31], v[128:143]
    v_exp_f32 v115, v115
    v_exp_f32 v116, v116
    v_exp_f32_e64 v117, v117
    v_smfmac_f32_32x32x32_bf16 v[96:111], v[200:203], v[160:167], v240
    buffer_load_dwordx4 v[200:203], v241, s[52:55], s74 offen offset:2048 sc1
    v_exp_f32 v118, v118
    v_exp_f32 v119, v119
    v_exp_f32_e64 v120, v120
    v_smfmac_f32_32x32x32_bf16 v[96:111], v[204:207], v[168:175], v240
    buffer_load_dwordx4 v[204:207], v241, s[52:55], s74 offen offset:3072 sc1
    v_exp_f32 v121, v121
    v_exp_f32 v122, v122
    v_exp_f32 v123, v123
    v_exp_f32 v124, v124
    v_exp_f32 v125, v125
    v_exp_f32 v126, v126
    v_exp_f32_e64 v127, v127
    v_mfma_f32_32x32x16_bf16 v[144:159], v[208:211], v[32:35], 0
    s_add_u32 s76, s74, 4096
    v_exp_f32 v128, v128
    v_exp_f32 v129, v129
    v_exp_f32_e64 v130, v130
    v_mfma_f32_32x32x16_bf16 v[144:159], v[212:215], v[36:39], v[144:159]
    v_exp_f32 v131, v131
    v_exp_f32 v132, v132
    v_exp_f32_e64 v133, v133
    v_smfmac_f32_32x32x32_bf16 v[48:63], v[216:219], v[112:119], v240
    v_exp_f32 v134, v134
    v_exp_f32 v135, v135
    v_exp_f32_e64 v136, v136
    v_smfmac_f32_32x32x32_bf16 v[48:63], v[220:223], v[120:127], v240
    v_exp_f32 v137, v137
    v_exp_f32 v138, v138
    v_exp_f32 v139, v139
    v_exp_f32 v140, v140
    v_exp_f32 v141, v141
    v_exp_f32 v142, v142
    v_exp_f32_e64 v143, v143
    v_mfma_f32_32x32x16_bf16 v[160:175], v[208:211], v[40:43], 0
    v_exp_f32 v144, v144
    v_exp_f32 v145, v145
    v_exp_f32_e64 v146, v146
    v_mfma_f32_32x32x16_bf16 v[160:175], v[212:215], v[44:47], v[160:175]
    s_waitcnt vmcnt(8)
    s_addk_i32 s74, 4096
    v_exp_f32 v147, v147
    v_exp_f32 v148, v148
    v_exp_f32_e64 v149, v149
    v_smfmac_f32_32x32x32_bf16 v[64:79], v[216:219], v[128:135], v240
    buffer_load_dwordx4 v[208:211], v241, s[52:55], s76 offen offset:0 sc1
    v_exp_f32 v150, v150
    v_exp_f32 v151, v151
    v_exp_f32_e64 v152, v152
    v_smfmac_f32_32x32x32_bf16 v[64:79], v[220:223], v[136:143], v240
    buffer_load_dwordx4 v[212:215], v241, s[52:55], s76 offen offset:1024 sc1
    v_exp_f32 v153, v153
    v_exp_f32 v154, v154
    v_exp_f32 v155, v155
    v_exp_f32 v156, v156
    v_exp_f32 v157, v157
    v_exp_f32 v158, v158
    v_exp_f32_e64 v159, v159
    v_mfma_f32_32x32x16_bf16 v[112:127], v[224:227], v[16:19], 0
    v_exp_f32 v160, v160
    v_exp_f32 v161, v161
    v_exp_f32_e64 v162, v162
    v_mfma_f32_32x32x16_bf16 v[112:127], v[228:231], v[20:23], v[112:127]
    v_exp_f32 v163, v163
    v_exp_f32 v164, v164
    v_exp_f32_e64 v165, v165
    v_smfmac_f32_32x32x32_bf16 v[80:95], v[216:219], v[144:151], v240
    v_exp_f32 v166, v166
    v_exp_f32 v167, v167
    v_exp_f32_e64 v168, v168
    v_smfmac_f32_32x32x32_bf16 v[80:95], v[220:223], v[152:159], v240
    v_exp_f32 v169, v169
    v_exp_f32 v170, v170
    v_exp_f32 v171, v171
    v_exp_f32 v172, v172
    v_exp_f32 v173, v173
    v_exp_f32 v174, v174
    v_exp_f32_e64 v175, v175
    v_mfma_f32_32x32x16_bf16 v[128:143], v[224:227], v[24:27], 0
    v_exp_f32 v112, v112
    v_exp_f32 v113, v113
    v_exp_f32_e64 v114, v114
    v_mfma_f32_32x32x16_bf16 v[128:143], v[228:231], v[28:31], v[128:143]
    v_exp_f32 v115, v115
    v_exp_f32 v116, v116
    v_exp_f32_e64 v117, v117
    v_smfmac_f32_32x32x32_bf16 v[96:111], v[216:219], v[160:167], v240
    buffer_load_dwordx4 v[216:219], v241, s[52:55], s74 offen offset:2048 sc1
    v_exp_f32 v118, v118
    v_exp_f32 v119, v119
    v_exp_f32_e64 v120, v120
    v_smfmac_f32_32x32x32_bf16 v[96:111], v[220:223], v[168:175], v240
    buffer_load_dwordx4 v[220:223], v241, s[52:55], s74 offen offset:3072 sc1
    v_exp_f32 v121, v121
    v_exp_f32 v122, v122
    v_exp_f32 v123, v123
    v_exp_f32 v124, v124
    v_exp_f32 v125, v125
    v_exp_f32 v126, v126
    v_exp_f32_e64 v127, v127
    v_mfma_f32_32x32x16_bf16 v[144:159], v[224:227], v[32:35], 0
    s_add_u32 s76, s74, 4096
    v_exp_f32 v128, v128
    v_exp_f32 v129, v129
    v_exp_f32_e64 v130, v130
    v_mfma_f32_32x32x16_bf16 v[144:159], v[228:231], v[36:39], v[144:159]
    v_exp_f32 v131, v131
    v_exp_f32 v132, v132
    v_exp_f32_e64 v133, v133
    v_smfmac_f32_32x32x32_bf16 v[48:63], v[232:235], v[112:119], v240
    v_exp_f32 v134, v134
    v_exp_f32 v135, v135
    v_exp_f32_e64 v136, v136
    v_smfmac_f32_32x32x32_bf16 v[48:63], v[236:239], v[120:127], v240
    v_exp_f32 v137, v137
    v_exp_f32 v138, v138
    v_exp_f32 v139, v139
    v_exp_f32 v140, v140
    v_exp_f32 v141, v141
    v_exp_f32 v142, v142
    v_exp_f32_e64 v143, v143
    v_mfma_f32_32x32x16_bf16 v[160:175], v[224:227], v[40:43], 0
    v_exp_f32 v144, v144
    v_exp_f32 v145, v145
    v_exp_f32_e64 v146, v146
    v_mfma_f32_32x32x16_bf16 v[160:175], v[228:231], v[44:47], v[160:175]
    s_waitcnt vmcnt(8)
    s_addk_i32 s74, 4096
    v_exp_f32 v147, v147
    v_exp_f32 v148, v148
    v_exp_f32_e64 v149, v149
    v_smfmac_f32_32x32x32_bf16 v[64:79], v[232:235], v[128:135], v240
    buffer_load_dwordx4 v[224:227], v241, s[52:55], s76 offen offset:0 sc1
    v_exp_f32 v150, v150
    v_exp_f32 v151, v151
    v_exp_f32_e64 v152, v152
    v_smfmac_f32_32x32x32_bf16 v[64:79], v[236:239], v[136:143], v240
    buffer_load_dwordx4 v[228:231], v241, s[52:55], s76 offen offset:1024 sc1
    v_exp_f32 v153, v153
    v_exp_f32 v154, v154
    v_exp_f32 v155, v155
    v_exp_f32 v156, v156
    v_exp_f32 v157, v157
    v_exp_f32 v158, v158
    v_exp_f32_e64 v159, v159
    v_mfma_f32_32x32x16_bf16 v[112:127], v[176:179], v[16:19], 0
    v_exp_f32 v160, v160
    v_exp_f32 v161, v161
    v_exp_f32_e64 v162, v162
    v_mfma_f32_32x32x16_bf16 v[112:127], v[180:183], v[20:23], v[112:127]
    v_exp_f32 v163, v163
    v_exp_f32 v164, v164
    v_exp_f32_e64 v165, v165
    v_smfmac_f32_32x32x32_bf16 v[80:95], v[232:235], v[144:151], v240
    v_exp_f32 v166, v166
    v_exp_f32 v167, v167
    v_exp_f32_e64 v168, v168
    v_smfmac_f32_32x32x32_bf16 v[80:95], v[236:239], v[152:159], v240
    v_exp_f32 v169, v169
    v_exp_f32 v170, v170
    v_exp_f32 v171, v171
    v_exp_f32 v172, v172
    v_exp_f32 v173, v173
    v_exp_f32 v174, v174
    v_exp_f32_e64 v175, v175
    s_add_u32 s75, s75, 1
    s_cmp_lt_u32 s75, 3
    s_cbranch_scc1 L_attn
    s_nop 0
    v_mfma_f32_32x32x16_bf16 v[128:143], v[176:179], v[24:27], 0
    v_exp_f32 v112, v112
    v_exp_f32 v113, v113
    v_exp_f32_e64 v114, v114
    v_mfma_f32_32x32x16_bf16 v[128:143], v[180:183], v[28:31], v[128:143]
    v_exp_f32 v115, v115
    v_exp_f32 v116, v116
    v_exp_f32_e64 v117, v117
    v_smfmac_f32_32x32x32_bf16 v[96:111], v[232:235], v[160:167], v240
    v_exp_f32 v118, v118
    v_exp_f32 v119, v119
    v_exp_f32_e64 v120, v120
    v_smfmac_f32_32x32x32_bf16 v[96:111], v[236:239], v[168:175], v240
    v_exp_f32 v121, v121
    v_exp_f32 v122, v122
    v_exp_f32 v123, v123
    v_exp_f32 v124, v124
    v_exp_f32 v125, v125
    v_exp_f32 v126, v126
    v_exp_f32_e64 v127, v127
    buffer_load_dwordx4 v[232:235], v241, s[52:55], s74 offen offset:2048 sc1
    buffer_load_dwordx4 v[236:239], v241, s[52:55], s74 offen offset:3072 sc1
    v_mfma_f32_32x32x16_bf16 v[144:159], v[176:179], v[32:35], 0
    v_exp_f32 v128, v128
    v_exp_f32 v129, v129
    v_exp_f32_e64 v130, v130
    v_mfma_f32_32x32x16_bf16 v[144:159], v[180:183], v[36:39], v[144:159]
    v_exp_f32 v131, v131
    v_exp_f32 v132, v132
    v_exp_f32_e64 v133, v133
    v_smfmac_f32_32x32x32_bf16 v[48:63], v[184:187], v[112:119], v240
    v_exp_f32 v134, v134
    v_exp_f32 v135, v135
    v_exp_f32_e64 v136, v136
    v_smfmac_f32_32x32x32_bf16 v[48:63], v[188:191], v[120:127], v240
    v_exp_f32 v137, v137
    v_exp_f32 v138, v138
    v_exp_f32 v139, v139
    v_exp_f32 v140, v140
    v_exp_f32 v141, v141
    v_exp_f32 v142, v142
    v_exp_f32_e64 v143, v143
    v_mfma_f32_32x32x16_bf16 v[160:175], v[176:179], v[40:43], 0
    v_exp_f32 v144, v144
    v_exp_f32 v145, v145
    v_exp_f32_e64 v146, v146
    v_mfma_f32_32x32x16_bf16 v[160:175], v[180:183], v[44:47], v[160:175]
    v_exp_f32 v147, v147
    v_exp_f32 v148, v148
    v_exp_f32_e64 v149, v149
    v_smfmac_f32_32x32x32_bf16 v[64:79], v[184:187], v[128:135], v240
    v_exp_f32 v150, v150
    v_exp_f32 v151, v151
    v_exp_f32_e64 v152, v152
    v_smfmac_f32_32x32x32_bf16 v[64:79], v[188:191], v[136:143], v240
    v_exp_f32 v153, v153
    v_exp_f32 v154, v154
    v_exp_f32 v155, v155
    v_exp_f32 v156, v156
    v_exp_f32 v157, v157
    v_exp_f32 v158, v158
    v_exp_f32_e64 v159, v159
    s_waitcnt vmcnt(8)
    s_nop 0
    v_mfma_f32_32x32x16_bf16 v[112:127], v[192:195], v[24:27], 0
    v_exp_f32 v160, v160
    v_exp_f32 v161, v161
    v_exp_f32_e64 v162, v162
    v_mfma_f32_32x32x16_bf16 v[112:127], v[196:199], v[28:31], v[112:127]
    v_exp_f32 v163, v163
    v_exp_f32 v164, v164
    v_exp_f32_e64 v165, v165
    v_smfmac_f32_32x32x32_bf16 v[80:95], v[184:187], v[144:151], v240
    v_exp_f32 v166, v166
    v_exp_f32 v167, v167
    v_exp_f32_e64 v168, v168
    v_smfmac_f32_32x32x32_bf16 v[80:95], v[188:191], v[152:159], v240
    v_exp_f32 v169, v169
    v_exp_f32 v170, v170
    v_exp_f32 v171, v171
    v_exp_f32 v172, v172
    v_exp_f32 v173, v173
    v_exp_f32 v174, v174
    v_exp_f32_e64 v175, v175
    s_waitcnt vmcnt(4)
    s_nop 0
    v_mfma_f32_32x32x16_bf16 v[128:143], v[208:211], v[24:27], 0
    v_exp_f32 v112, v112
    v_exp_f32 v113, v113
    v_exp_f32_e64 v114, v114
    v_mfma_f32_32x32x16_bf16 v[128:143], v[212:215], v[28:31], v[128:143]
    v_exp_f32 v115, v115
    v_exp_f32 v116, v116
    v_exp_f32_e64 v117, v117
    v_smfmac_f32_32x32x32_bf16 v[96:111], v[184:187], v[160:167], v240
    v_exp_f32 v118, v118
    v_exp_f32 v119, v119
    v_exp_f32_e64 v120, v120
    v_smfmac_f32_32x32x32_bf16 v[96:111], v[188:191], v[168:175], v240
    v_exp_f32 v121, v121
    v_exp_f32 v122, v122
    v_exp_f32 v123, v123
    v_exp_f32 v124, v124
    v_exp_f32 v125, v125
    v_exp_f32 v126, v126
    v_exp_f32_e64 v127, v127
    s_waitcnt vmcnt(2)
    s_nop 0
    v_mfma_f32_32x32x16_bf16 v[144:159], v[224:227], v[24:27], 0
    v_exp_f32 v128, v128
    v_exp_f32 v129, v129
    v_exp_f32_e64 v130, v130
    v_mfma_f32_32x32x16_bf16 v[144:159], v[228:231], v[28:31], v[144:159]
    v_exp_f32 v131, v131
    v_exp_f32 v132, v132
    v_exp_f32_e64 v133, v133
    v_smfmac_f32_32x32x32_bf16 v[64:79], v[200:203], v[112:119], v240
    v_exp_f32 v134, v134
    v_exp_f32 v135, v135
    v_exp_f32_e64 v136, v136
    v_smfmac_f32_32x32x32_bf16 v[64:79], v[204:207], v[120:127], v240
    v_exp_f32 v137, v137
    v_exp_f32 v138, v138
    v_exp_f32 v139, v139
    v_exp_f32 v140, v140
    v_exp_f32 v141, v141
    v_exp_f32 v142, v142
    v_exp_f32_e64 v143, v143
    v_mfma_f32_32x32x16_bf16 v[160:175], v[192:195], v[32:35], 0
    v_exp_f32 v144, v144
    v_exp_f32 v145, v145
    v_exp_f32_e64 v146, v146
    v_mfma_f32_32x32x16_bf16 v[160:175], v[196:199], v[36:39], v[160:175]
    v_exp_f32 v147, v147
    v_exp_f32 v148, v148
    v_exp_f32_e64 v149, v149
    v_smfmac_f32_32x32x32_bf16 v[64:79], v[216:219], v[128:135], v240
    v_exp_f32 v150, v150
    v_exp_f32 v151, v151
    v_exp_f32_e64 v152, v152
    v_smfmac_f32_32x32x32_bf16 v[64:79], v[220:223], v[136:143], v240
    v_exp_f32 v153, v153
    v_exp_f32 v154, v154
    v_exp_f32 v155, v155
    v_exp_f32 v156, v156
    v_exp_f32 v157, v157
    v_exp_f32 v158, v158
    v_exp_f32_e64 v159, v159
    s_waitcnt vmcnt(0)
    s_nop 0
    ds_read_b32 v244, v242 offset:12
    v_mfma_f32_32x32x16_bf16 v[112:127], v[208:211], v[32:35], 0
    v_exp_f32 v160, v160
    v_exp_f32 v161, v161
    v_exp_f32_e64 v162, v162
    v_mfma_f32_32x32x16_bf16 v[112:127], v[212:215], v[36:39], v[112:127]
    v_exp_f32 v163, v163
    v_exp_f32 v164, v164
    v_exp_f32_e64 v165, v165
    v_smfmac_f32_32x32x32_bf16 v[64:79], v[232:235], v[144:151], v240
    v_exp_f32 v166, v166
    v_exp_f32 v167, v167
    v_exp_f32_e64 v168, v168
    v_smfmac_f32_32x32x32_bf16 v[64:79], v[236:239], v[152:159], v240
    v_exp_f32 v169, v169
    v_exp_f32 v170, v170
    v_exp_f32 v171, v171
    v_exp_f32 v172, v172
    v_exp_f32 v173, v173
    v_exp_f32 v174, v174
    v_exp_f32_e64 v175, v175
    s_waitcnt lgkmcnt(0)
    v_readfirstlane_b32 s71, v244
    s_nop 0
    s_cmp_ge_u32 s71, 4
    s_cbranch_scc1 L_s3ok
    s_mov_b32 s70, 0
L_lw_21:
    ds_read_b32 v244, v242 offset:12
    s_waitcnt lgkmcnt(0)
    v_readfirstlane_b32 s71, v244
    s_nop 0
    s_cmp_ge_u32 s71, 4
    s_cbranch_scc1 L_lwd_22
    s_add_u32 s70, s70, 1
    s_cmp_lt_u32 s70, 800000
    s_cbranch_scc1 L_lw_21
L_lwd_22:
L_s3ok:
.p2align 3
    v_mfma_f32_32x32x16_bf16 v[128:143], v[224:227], v[32:35], 0
    v_exp_f32 v112, v112
    v_exp_f32 v113, v113
    v_exp_f32_e64 v114, v114
    v_mfma_f32_32x32x16_bf16 v[128:143], v[228:231], v[36:39], v[128:143]
    ds_write_b128 v9, v[64:67] offset:0
    v_exp_f32 v115, v115
    v_exp_f32 v116, v116
    v_exp_f32_e64 v117, v117
    v_smfmac_f32_32x32x32_bf16 v[80:95], v[200:203], v[160:167], v240
    ds_write_b128 v9, v[68:71] offset:1024
    v_exp_f32 v118, v118
    v_exp_f32 v119, v119
    v_exp_f32_e64 v120, v120
    v_smfmac_f32_32x32x32_bf16 v[80:95], v[204:207], v[168:175], v240
    ds_write_b128 v9, v[72:75] offset:2048
    v_exp_f32 v121, v121
    v_exp_f32 v122, v122
    v_exp_f32 v123, v123
    v_exp_f32 v124, v124
    ds_write_b128 v9, v[76:79] offset:3072
    v_exp_f32 v125, v125
    v_exp_f32 v126, v126
    s_mov_b64 exec, 1
    ds_add_u32 v251, v243
    s_mov_b64 exec, -1
    v_exp_f32_e64 v127, v127
    v_mfma_f32_32x32x16_bf16 v[144:159], v[192:195], v[40:43], 0
    v_exp_f32 v128, v128
    v_exp_f32 v129, v129
    v_exp_f32_e64 v130, v130
    v_mfma_f32_32x32x16_bf16 v[144:159], v[196:199], v[44:47], v[144:159]
    v_exp_f32 v131, v131
    v_exp_f32 v132, v132
    v_exp_f32_e64 v133, v133
    v_smfmac_f32_32x32x32_bf16 v[80:95], v[216:219], v[112:119], v240
    v_exp_f32 v134, v134
    v_exp_f32 v135, v135
    v_exp_f32_e64 v136, v136
    v_smfmac_f32_32x32x32_bf16 v[80:95], v[220:223], v[120:127], v240
    v_exp_f32 v137, v137
    v_exp_f32 v138, v138
    v_exp_f32 v139, v139
    v_exp_f32 v140, v140
    v_exp_f32 v141, v141
    v_exp_f32 v142, v142
    v_exp_f32_e64 v143, v143
    v_mfma_f32_32x32x16_bf16 v[160:175], v[208:211], v[40:43], 0
    v_exp_f32 v144, v144
    v_exp_f32 v145, v145
    v_exp_f32_e64 v146, v146
    v_mfma_f32_32x32x16_bf16 v[160:175], v[212:215], v[44:47], v[160:175]
    v_exp_f32 v147, v147
    v_exp_f32 v148, v148
    v_exp_f32_e64 v149, v149
    v_smfmac_f32_32x32x32_bf16 v[80:95], v[232:235], v[128:135], v240
    v_exp_f32 v150, v150
    v_exp_f32 v151, v151
    v_exp_f32_e64 v152, v152
    v_smfmac_f32_32x32x32_bf16 v[80:95], v[236:239], v[136:143], v240
    v_exp_f32 v153, v153
    v_exp_f32 v154, v154
    v_exp_f32 v155, v155
    v_exp_f32 v156, v156
    v_exp_f32 v157, v157
    v_exp_f32 v158, v158
    v_exp_f32_e64 v159, v159
    v_mfma_f32_32x32x16_bf16 v[112:127], v[224:227], v[40:43], 0
    v_exp_f32 v160, v160
    v_exp_f32 v161, v161
    v_exp_f32_e64 v162, v162
    v_mfma_f32_32x32x16_bf16 v[112:127], v[228:231], v[44:47], v[112:127]
    ds_write_b128 v10, v[80:83] offset:0
    v_exp_f32 v163, v163
    v_exp_f32 v164, v164
    v_exp_f32_e64 v165, v165
    v_smfmac_f32_32x32x32_bf16 v[96:111], v[200:203], v[144:151], v240
    ds_write_b128 v10, v[84:87] offset:1024
    v_exp_f32 v166, v166
    v_exp_f32 v167, v167
    v_exp_f32_e64 v168, v168
    v_smfmac_f32_32x32x32_bf16 v[96:111], v[204:207], v[152:159], v240
    ds_write_b128 v10, v[88:91] offset:2048
    v_exp_f32 v169, v169
    v_exp_f32 v170, v170
    v_exp_f32 v171, v171
    v_exp_f32 v172, v172
    ds_write_b128 v10, v[92:95] offset:3072
    v_exp_f32 v173, v173
    v_exp_f32 v174, v174
    s_mov_b64 exec, 1
    ds_add_u32 v252, v243
    s_mov_b64 exec, -1
    v_exp_f32_e64 v175, v175
    ds_read_b32 v244, v250
    ds_read_b32 v13, v13
    v_mfma_f32_32x32x16_bf16 v[128:143], v[192:195], v[16:19], 0
    v_exp_f32 v112, v112
    v_exp_f32 v113, v113
    v_exp_f32_e64 v114, v114
    v_mfma_f32_32x32x16_bf16 v[128:143], v[196:199], v[20:23], v[128:143]
    v_exp_f32 v115, v115
    v_exp_f32 v116, v116
    v_exp_f32_e64 v117, v117
    v_smfmac_f32_32x32x32_bf16 v[96:111], v[216:219], v[160:167], v240
    v_exp_f32 v118, v118
    v_exp_f32 v119, v119
    v_exp_f32_e64 v120, v120
    v_smfmac_f32_32x32x32_bf16 v[96:111], v[220:223], v[168:175], v240
    v_exp_f32 v121, v121
    v_exp_f32 v122, v122
    v_exp_f32 v123, v123
    v_exp_f32 v124, v124
    v_exp_f32 v125, v125
    v_exp_f32 v126, v126
    v_exp_f32_e64 v127, v127
    s_mov_b32 s70, 0
    s_waitcnt lgkmcnt(0)
L_ox_23:
    v_readfirstlane_b32 s71, v244
    s_nop 0
    s_bfe_u32 s71, s71, 0x80000
    s_cmp_ge_u32 s71, 2
    s_cbranch_scc1 L_oxd_24
    ds_read_b32 v244, v250
    s_add_u32 s70, s70, 1
    s_cmp_lt_u32 s70, 800000
    s_waitcnt lgkmcnt(0)
    s_cbranch_scc1 L_ox_23
L_oxd_24:
.p2align 3
    v_mfma_f32_32x32x16_bf16 v[144:159], v[208:211], v[16:19], 0
    ds_read_b128 v[64:67], v12 offset:0
    v_exp_f32 v128, v128
    v_exp_f32 v129, v129
    v_exp_f32_e64 v130, v130
    ds_read_b128 v[68:71], v12 offset:1024
    v_mfma_f32_32x32x16_bf16 v[144:159], v[212:215], v[20:23], v[144:159]
    ds_read_b128 v[72:75], v12 offset:2048
    v_exp_f32 v131, v131
    v_exp_f32 v132, v132
    v_exp_f32_e64 v133, v133
    ds_read_b128 v[76:79], v12 offset:3072
    v_smfmac_f32_32x32x32_bf16 v[96:111], v[232:235], v[112:119], v240
    ds_read_b128 v[80:83], v12 offset:4096
    v_exp_f32 v134, v134
    v_exp_f32 v135, v135
    v_exp_f32_e64 v136, v136
    ds_read_b128 v[84:87], v12 offset:5120
    v_smfmac_f32_32x32x32_bf16 v[96:111], v[236:239], v[120:127], v240
    ds_read_b128 v[88:91], v12 offset:6144
    v_exp_f32 v137, v137
    v_exp_f32 v138, v138
    v_exp_f32 v139, v139
    v_exp_f32 v140, v140
    ds_read_b128 v[92:95], v12 offset:7168
    v_exp_f32 v141, v141
    v_exp_f32 v142, v142
    v_exp_f32_e64 v143, v143
    v_mfma_f32_32x32x16_bf16 v[160:175], v[224:227], v[16:19], 0
    v_exp_f32 v144, v144
    v_exp_f32 v145, v145
    v_exp_f32_e64 v146, v146
    v_mfma_f32_32x32x16_bf16 v[160:175], v[228:231], v[20:23], v[160:175]
    ds_write_b128 v11, v[96:99] offset:0
    v_exp_f32 v147, v147
    v_exp_f32 v148, v148
    v_exp_f32_e64 v149, v149
    v_smfmac_f32_32x32x32_bf16 v[48:63], v[200:203], v[128:135], v240
    ds_write_b128 v11, v[100:103] offset:1024
    v_exp_f32 v150, v150
    v_exp_f32 v151, v151
    v_exp_f32_e64 v152, v152
    v_smfmac_f32_32x32x32_bf16 v[48:63], v[204:207], v[136:143], v240
    ds_write_b128 v11, v[104:107] offset:2048
    v_exp_f32 v153, v153
    v_exp_f32 v154, v154
    v_exp_f32 v155, v155
    v_exp_f32 v156, v156
    ds_write_b128 v11, v[108:111] offset:3072
    v_exp_f32 v157, v157
    v_exp_f32 v158, v158
    s_mov_b64 exec, 1
    ds_add_u32 v253, v254
    s_mov_b64 exec, -1
    v_exp_f32_e64 v159, v159
    s_waitcnt lgkmcnt(5)
    s_nop 0
    v_pk_add_f32 v[64:65], v[64:65], v[80:81]
    v_pk_add_f32 v[66:67], v[66:67], v[82:83]
    v_pk_add_f32 v[68:69], v[68:69], v[84:85]
    v_pk_add_f32 v[70:71], v[70:71], v[86:87]
    v_pk_add_f32 v[72:73], v[72:73], v[88:89]
    v_pk_add_f32 v[74:75], v[74:75], v[90:91]
    v_pk_add_f32 v[76:77], v[76:77], v[92:93]
    v_pk_add_f32 v[78:79], v[78:79], v[94:95]
    v_exp_f32 v160, v160
    v_exp_f32 v161, v161
    v_exp_f32_e64 v162, v162
    v_exp_f32 v163, v163
    v_exp_f32 v164, v164
    v_exp_f32_e64 v165, v165
    v_smfmac_f32_32x32x32_bf16 v[48:63], v[216:219], v[144:151], v240
    v_exp_f32 v166, v166
    v_exp_f32 v167, v167
    v_exp_f32_e64 v168, v168
    v_smfmac_f32_32x32x32_bf16 v[48:63], v[220:223], v[152:159], v240
    ds_read_b32 v244, v250
    v_exp_f32 v169, v169
    v_exp_f32 v170, v170
    v_exp_f32 v171, v171
    v_exp_f32 v172, v172
    v_exp_f32 v173, v173
    v_exp_f32 v174, v174
    v_exp_f32_e64 v175, v175
    s_setprio 3
    v_smfmac_f32_32x32x32_bf16 v[48:63], v[232:235], v[160:167], v240
    s_mov_b32 s70, 0
    s_waitcnt lgkmcnt(0)
L_ox_25:
    v_readfirstlane_b32 s71, v244
    s_nop 0
    s_bfe_u32 s71, s71, 0x80008
    s_cmp_ge_u32 s71, 1
    s_cbranch_scc1 L_oxd_26
    ds_read_b32 v244, v250
    s_add_u32 s70, s70, 1
    s_cmp_lt_u32 s70, 800000
    s_waitcnt lgkmcnt(0)
    s_cbranch_scc1 L_ox_25
L_oxd_26:
    ds_read_b128 v[100:103], v12 offset:9216
    ds_read_b128 v[96:99], v12 offset:8192
    ds_read_b128 v[104:107], v12 offset:10240
    ds_read_b128 v[108:111], v12 offset:11264
    v_smfmac_f32_32x32x32_bf16 v[48:63], v[236:239], v[168:175], v240
    s_mov_b64 exec, 1
    ds_add_u32 v242, v243 offset:32
    s_mov_b64 exec, -1
    s_waitcnt lgkmcnt(4)
    v_add_f32 v68, v68, v100
    v_add_f32 v69, v69, v101
    v_add_f32 v70, v70, v102
    v_add_f32 v71, v71, v103
    s_waitcnt lgkmcnt(3)
    v_add_f32 v64, v64, v96
    v_add_f32 v65, v65, v97
    v_add_f32 v66, v66, v98
    v_add_f32 v67, v67, v99
    s_waitcnt lgkmcnt(2)
    v_add_f32 v72, v72, v104
    v_add_f32 v73, v73, v105
    v_add_f32 v74, v74, v106
    v_add_f32 v75, v75, v107
    s_waitcnt lgkmcnt(1)
    v_add_f32 v76, v76, v108
    v_add_f32 v77, v77, v109
    v_add_f32 v78, v78, v110
    v_add_f32 v79, v79, v111
    v_add_f32 v54, v54, v70
    v_add_f32 v55, v55, v71
    v_add_f32 v52, v52, v68
    v_add_f32 v53, v53, v69
    v_rcp_f32 v14, v55
    v_add_f32 v50, v50, v66
    v_add_f32 v51, v51, v67
    v_add_f32 v48, v48, v64
    v_add_f32 v49, v49, v65
    v_mul_f32 v14, v14, v13
    v_subrev_u32 v15, 0x2f800000, v55
    v_cmp_le_u32 vcc, 0x30000000, v15
    v_add_f32 v58, v58, v74
    v_add_f32 v59, v59, v75
    v_add_f32 v56, v56, v72
    v_add_f32 v57, v57, v73
    v_add_f32 v62, v62, v78
    v_add_f32 v63, v63, v79
    v_add_f32 v60, v60, v76
    v_add_f32 v61, v61, v77
    s_cbranch_vccnz L_fb
L_fbret:
    v_mul_f32 v48, v48, v14
    v_mul_f32 v49, v49, v14
    v_mul_f32 v50, v50, v14
    v_mul_f32 v51, v51, v14
    v_mul_f32 v52, v52, v14
    v_mul_f32 v53, v53, v14
    v_mul_f32 v54, v54, v14
    v_mul_f32 v55, v55, v14
    v_mul_f32 v56, v56, v14
    v_mul_f32 v57, v57, v14
    v_mul_f32 v58, v58, v14
    v_mul_f32 v59, v59, v14
    v_mul_f32 v60, v60, v14
    v_mul_f32 v61, v61, v14
    v_mul_f32 v62, v62, v14
    v_mul_f32 v63, v63, v14
    v_cvt_pk_bf16_f32 v16, v48, v49
    v_cvt_pk_bf16_f32 v17, v50, v51
    v_cvt_pk_bf16_f32 v18, v52, v53
    v_cvt_pk_bf16_f32 v19, v54, s39
    buffer_store_dwordx4 v[16:19], v241, s[48:51], s77 offen sc1
    v_cvt_pk_bf16_f32 v20, v56, v57
    v_cvt_pk_bf16_f32 v21, v58, v59
    v_cvt_pk_bf16_f32 v22, v60, v61
    v_cvt_pk_bf16_f32 v23, v62, s39
    buffer_store_dwordx4 v[20:23], v241, s[48:51], s77 offen offset:1024 sc1
    v_lshlrev_b32 v10, 5, v241
    s_mov_b64 exec, 0x7f
    buffer_store_dword v248, v10, s[48:51], s79 offen sc1
    s_mov_b64 exec, -1
    s_setprio 0
    s_branch L_final
L_helper:
    s_lshl_b32 s10, s13, 7
    s_mov_b32 m0, s68
    s_add_u32 s8, s10, s66
    buffer_load_dwordx4 v3, s[44:47], s8 offen lds
    s_add_u32 m0, s68, 1024
    s_add_u32 s68, s68, s56
    buffer_load_dwordx4 v4, s[44:47], s8 offen lds
    s_mov_b32 m0, s69
    s_add_u32 s8, s10, s67
    buffer_load_dwordx4 v3, s[44:47], s8 offen lds
    s_add_u32 m0, s69, 1024
    s_add_u32 s69, s69, s57
    buffer_load_dwordx4 v4, s[44:47], s8 offen lds
    s_add_u32 s13, s13, 1
    s_cmp_eq_u32 s13, 7
    s_cselect_b32 s13, 0, s13
    s_lshl_b32 s10, s13, 7
    s_mov_b32 m0, s68
    s_add_u32 s8, s10, s66
    buffer_load_dwordx4 v3, s[44:47], s8 offen lds
    s_add_u32 m0, s68, 1024
    s_add_u32 s68, s68, s56
    buffer_load_dwordx4 v4, s[44:47], s8 offen lds
    s_mov_b32 m0, s69
    s_add_u32 s8, s10, s67
    buffer_load_dwordx4 v3, s[44:47], s8 offen lds
    s_add_u32 m0, s69, 1024
    s_add_u32 s69, s69, s57
    buffer_load_dwordx4 v4, s[44:47], s8 offen lds
    s_add_u32 s13, s13, 1
    s_cmp_eq_u32 s13, 7
    s_cselect_b32 s13, 0, s13
    s_lshl_b32 s10, s13, 7
    s_mov_b32 m0, s68
    s_add_u32 s8, s10, s66
    buffer_load_dwordx4 v3, s[44:47], s8 offen lds
    s_add_u32 m0, s68, 1024
    s_add_u32 s68, s68, s56
    buffer_load_dwordx4 v4, s[44:47], s8 offen lds
    s_mov_b32 m0, s69
    s_add_u32 s8, s10, s67
    buffer_load_dwordx4 v3, s[44:47], s8 offen lds
    s_add_u32 m0, s69, 1024
    s_add_u32 s69, s69, s57
    buffer_load_dwordx4 v4, s[44:47], s8 offen lds
    s_add_u32 s13, s13, 1
    s_cmp_eq_u32 s13, 7
    s_cselect_b32 s13, 0, s13
    s_lshl_b32 s10, s13, 7
    s_mov_b32 m0, s68
    s_add_u32 s8, s10, s66
    buffer_load_dwordx4 v3, s[44:47], s8 offen lds
    s_add_u32 m0, s68, 1024
    s_add_u32 s68, s68, s56
    buffer_load_dwordx4 v4, s[44:47], s8 offen lds
    s_mov_b32 m0, s69
    s_add_u32 s8, s10, s67
    buffer_load_dwordx4 v3, s[44:47], s8 offen lds
    s_add_u32 m0, s69, 1024
    s_add_u32 s69, s69, s57
    buffer_load_dwordx4 v4, s[44:47], s8 offen lds
    s_add_u32 s13, s13, 1
    s_cmp_eq_u32 s13, 7
    s_cselect_b32 s13, 0, s13
    v_and_b32 v8, 31, v1
    v_lshrrev_b32 v9, 5, v1
    v_lshrrev_b32 v10, 1, v8
    v_and_b32 v10, 7, v10
    v_xor_b32 v10, v10, v9
    s_lshl_b32 s8, s7, 12
    v_lshl_add_u32 v11, v8, 7, s8
    v_lshl_add_u32 v12, v10, 4, v11
    v_xor_b32 v13, 32, v12
    v_xor_b32 v14, 64, v12
    v_xor_b32 v15, 96, v12
    v_and_b32 v2, 15, v1
    v_lshrrev_b32 v2, 2, v2
    v_and_b32 v6, 3, v1
    v_lshlrev_b32 v6, 3, v6
    v_and_b32 v10, 16, v1
    v_lshl_add_u32 v6, v10, 1, v6
    v_add_u32 v7, 114688, v241
    s_mov_b32 s68, 0x3e8b97f6
    s_mov_b32 s69, s68
    s_lshl_b32 s8, s7, 11
    s_add_u32 s8, s8, 152576
    v_add_u32 v4, s8, v241
    s_lshl_b32 s8, s7, 7
    s_add_u32 s8, s8, 162816
    v_lshl_add_u32 v5, v8, 2, s8
    s_mov_b32 s72, 0x3fb8aa3b
    s_mov_b32 s73, s72
    s_mov_b32 s74, 0xbfb8aa3b
    s_mov_b32 s75, s74
    s_lshr_b32 s77, s5, 3
    s_and_b32 s78, s5, 7
    v_lshrrev_b32 v10, 3, v1
    v_mul_u32_u24 v10, 896, v10
    v_and_b32 v11, 7, v1
    v_lshl_add_u32 v247, v11, 4, v10
    s_mov_b32 s70, 0
L_lw_27:
    ds_read_b32 v244, v242 offset:36
    s_waitcnt lgkmcnt(0)
    v_readfirstlane_b32 s71, v244
    s_nop 0
    s_cmp_ge_u32 s71, 7
    s_cbranch_scc1 L_lwd_28
    s_sleep 1
    s_add_u32 s70, s70, 1
    s_cmp_lt_u32 s70, 800000
    s_cbranch_scc1 L_lw_27
L_lwd_28:
    s_waitcnt vmcnt(24)
    ds_read_b128 v[112:115], v12 offset:0
    ds_read_b128 v[116:119], v13 offset:0
    ds_read_b128 v[120:123], v14 offset:0
    ds_read_b128 v[124:127], v15 offset:0
    s_waitcnt vmcnt(20)
    ds_read_b128 v[128:131], v12 offset:16384
    ds_read_b128 v[132:135], v13 offset:16384
    ds_read_b128 v[136:139], v14 offset:16384
    ds_read_b128 v[140:143], v15 offset:16384
    s_waitcnt vmcnt(16)
    ds_read_b128 v[144:147], v12 offset:32768
    ds_read_b128 v[148:151], v13 offset:32768
    ds_read_b128 v[152:155], v14 offset:32768
    ds_read_b128 v[156:159], v15 offset:32768
    s_waitcnt vmcnt(12)
    s_waitcnt lgkmcnt(8)
    ds_read_b128 v[160:163], v12 offset:49152
    ds_read_b128 v[164:167], v13 offset:49152
    ds_read_b128 v[168:171], v14 offset:49152
    ds_read_b128 v[172:175], v15 offset:49152
    s_mov_b64 exec, 1
    ds_add_u32 v242, v243 offset:52
    s_mov_b64 exec, -1
    s_waitcnt vmcnt(8)
    v_add_u32 v12, 65536, v12
    v_add_u32 v13, 65536, v13
    v_add_u32 v14, 65536, v14
    v_add_u32 v15, 65536, v15
    s_waitcnt lgkmcnt(8)
    ds_read_b128 v[176:179], v12 offset:0
    ds_read_b128 v[180:183], v13 offset:0
    ds_read_b128 v[184:187], v14 offset:0
    ds_read_b128 v[188:191], v15 offset:0
    s_waitcnt vmcnt(4)
    s_waitcnt lgkmcnt(8)
    ds_read_b128 v[192:195], v12 offset:16384
    ds_read_b128 v[196:199], v13 offset:16384
    ds_read_b128 v[200:203], v14 offset:16384
    ds_read_b128 v[204:207], v15 offset:16384
    s_waitcnt vmcnt(0)
    s_waitcnt lgkmcnt(8)
    ds_read_b128 v[208:211], v12 offset:32768
    ds_read_b128 v[212:215], v13 offset:32768
    ds_read_b128 v[216:219], v14 offset:32768
    ds_read_b128 v[220:223], v15 offset:32768
    s_mov_b64 exec, 1
    ds_add_u32 v242, v243 offset:52
    s_mov_b64 exec, -1
    v_add_u32 v15, 57344, v241
    v_mul_u32_u24 v10, 72, v8
    v_lshl_add_u32 v10, v9, 3, v10
    s_mul_i32 s8, s7, 2304
    s_add_u32 s8, s8, 86016
    v_add_u32 v250, s8, v10
    v_lshl_add_u32 v10, v9, 2, v2
    v_mul_u32_u24 v10, 72, v10
    v_add_u32 v10, v10, v6
    s_mul_i32 s8, s7, 9216
    s_add_u32 s8, s8, 86016
    v_add_u32 v251, s8, v10
    s_lshl_b32 s8, s7, 11
    s_add_u32 s8, s8, 104448
    v_add_u32 v3, s8, v241
    v_and_b32 v11, 8, v1
    v_cmp_eq_u32 vcc, 0, v11
    v_and_b32 v12, 1, v1
    v_lshlrev_b32 v12, 4, v12
    v_mov_b32 v13, 0x3f80
    v_lshlrev_b32 v12, v12, v13
    v_cndmask_b32 v12, 0, v12, vcc
    v_bfe_u32 v11, v1, 1, 2
    v_cmp_eq_u32 vcc, 0, v11
    s_nop 1
    v_cndmask_b32 v252, 0, v12, vcc
    v_cmp_eq_u32 vcc, 1, v11
    s_nop 1
    v_cndmask_b32 v253, 0, v12, vcc
    v_cmp_eq_u32 vcc, 2, v11
    s_nop 1
    v_cndmask_b32 v254, 0, v12, vcc
    v_cmp_eq_u32 vcc, 3, v11
    s_nop 1
    v_cndmask_b32 v255, 0, v12, vcc
    v_mul_u32_u24 v10, 7, v9
    v_add_u32 v11, v10, v2
    v_min_u32 v12, 2, v2
    v_add_u32 v12, v12, v10
    v_add_u32 v12, 4, v12
    s_mul_i32 s56, s7, 14336
    s_cmp_ge_u32 s7, 2
    s_cselect_b32 s8, 86016, 0
    s_add_u32 s56, s56, s8
    v_add_u32 v6, s56, v6
    v_lshl_add_u32 v2, v11, 7, v6
    v_lshl_add_u32 v6, v12, 7, v6
    s_mov_b32 s8, s56
    s_cmp_eq_u32 s7, 0
    s_cselect_b32 s8, 31744, s8
    s_cmp_eq_u32 s7, 2
    s_cselect_b32 s8, 111616, s8
    v_mul_u32_u24 v8, 272, v8
    v_lshl_add_u32 v8, v9, 4, v8
    v_add_u32 v8, s8, v8
    v_lshrrev_b32 v9, 4, v1
    v_lshlrev_b32 v9, 12, v9
    v_and_b32 v10, 0xf0, v241
    v_add_u32 v9, v9, v10
    v_lshlrev_b32 v1, 7, v1
    s_mov_b32 s66, 0x8800
    s_mov_b32 s67, 0x8800
    s_mov_b32 s60, s22
    s_mov_b32 s61, s23
    s_mov_b32 s34, s42
    s_mov_b32 s35, s42
    s_mov_b32 s76, 0xffff
    s_setprio 2
    s_mov_b32 s70, 0
L_lw_29:
    ds_read_b32 v244, v242 offset:4
    s_waitcnt lgkmcnt(0)
    v_readfirstlane_b32 s71, v244
    s_nop 0
    s_cmp_ge_u32 s71, 1
    s_cbranch_scc1 L_lwd_30
    s_add_u32 s70, s70, 1
    s_cmp_lt_u32 s70, 800000
    s_cbranch_scc1 L_lw_29
L_lwd_30:
    s_lshl_b32 s8, s5, 11
    s_add_u32 s8, s8, 2883584
    buffer_load_dwordx4 v[80:83], v241, s[48:51], s8 offen sc1
    buffer_load_dwordx4 v[84:87], v241, s[48:51], s8 offen offset:1024 sc1
    s_mov_b32 s70, 0
L_lw_31:
    ds_read_b32 v244, v242 offset:40
    s_waitcnt lgkmcnt(0)
    v_readfirstlane_b32 s71, v244
    s_nop 0
    s_cmp_ge_u32 s71, 4
    s_cbranch_scc1 L_lwd_32
    s_add_u32 s70, s70, 1
    s_cmp_lt_u32 s70, 800000
    s_cbranch_scc1 L_lw_31
L_lwd_32:
    ds_read_b128 v[16:19], v7 offset:0
    ds_read_b128 v[20:23], v7 offset:1024
    ds_read_b128 v[24:27], v7 offset:2048
    ds_read_b128 v[28:31], v7 offset:3072
    ds_read_b128 v[32:35], v7 offset:4096
    ds_read_b32 v244, v242 offset:28
    ds_read_b128 v[36:39], v7 offset:5120
    ds_read_b128 v[40:43], v7 offset:6144
    ds_read_b128 v[44:47], v7 offset:7168
    s_waitcnt lgkmcnt(7)
    v_mfma_f32_32x32x16_bf16 v[48:63], v[16:19], v[112:115], 0
    s_waitcnt lgkmcnt(6)
    v_mfma_f32_32x32x16_bf16 v[48:63], v[20:23], v[116:119], v[48:63]
    s_waitcnt lgkmcnt(5)
    v_mfma_f32_32x32x16_bf16 v[48:63], v[24:27], v[120:123], v[48:63]
    s_waitcnt lgkmcnt(4)
    v_mfma_f32_32x32x16_bf16 v[48:63], v[28:31], v[124:127], v[48:63]
    s_waitcnt lgkmcnt(3)
    v_mfma_f32_32x32x16_bf16 v[48:63], v[32:35], v[128:131], v[48:63]
    s_waitcnt lgkmcnt(3)
    v_readfirstlane_b32 s71, v244
    s_nop 0
    s_cmp_ge_u32 s71, 4
    s_cbranch_scc1 L_pk_33
    s_mov_b32 s70, 0
L_lw_34:
    ds_read_b32 v244, v242 offset:28
    s_waitcnt lgkmcnt(0)
    v_readfirstlane_b32 s71, v244
    s_nop 0
    s_cmp_ge_u32 s71, 4
    s_cbranch_scc1 L_lwd_35
    s_add_u32 s70, s70, 1
    s_cmp_lt_u32 s70, 800000
    s_cbranch_scc1 L_lw_34
L_lwd_35:
L_pk_33:
    ds_read_b128 v[16:19], v7 offset:8192
    ds_read_b128 v[20:23], v7 offset:9216
    ds_read_b128 v[24:27], v7 offset:10240
    ds_read_b128 v[28:31], v7 offset:11264
    ds_read_b128 v[32:35], v7 offset:12288
    s_waitcnt lgkmcnt(7)
    v_mfma_f32_32x32x16_bf16 v[48:63], v[36:39], v[132:135], v[48:63]
    ds_read_b128 v[36:39], v7 offset:13312
    s_waitcnt lgkmcnt(7)
    v_mfma_f32_32x32x16_bf16 v[48:63], v[40:43], v[136:139], v[48:63]
    ds_read_b128 v[40:43], v7 offset:14336
    s_waitcnt lgkmcnt(7)
    v_mfma_f32_32x32x16_bf16 v[48:63], v[44:47], v[140:143], v[48:63]
    ds_read_b128 v[44:47], v7 offset:15360
    s_waitcnt lgkmcnt(7)
    v_mfma_f32_32x32x16_bf16 v[48:63], v[16:19], v[144:147], v[48:63]
    ds_read_b128 v[16:19], v7 offset:16384
    s_waitcnt lgkmcnt(7)
    v_mfma_f32_32x32x16_bf16 v[48:63], v[20:23], v[148:151], v[48:63]
    ds_read_b128 v[20:23], v7 offset:17408
    s_waitcnt lgkmcnt(7)
    v_mfma_f32_32x32x16_bf16 v[48:63], v[24:27], v[152:155], v[48:63]
    ds_read_b128 v[24:27], v7 offset:18432
    s_waitcnt lgkmcnt(7)
    v_mfma_f32_32x32x16_bf16 v[48:63], v[28:31], v[156:159], v[48:63]
    ds_read_b128 v[28:31], v7 offset:19456
    s_waitcnt lgkmcnt(7)
    v_mfma_f32_32x32x16_bf16 v[48:63], v[32:35], v[160:163], v[48:63]
    ds_read_b128 v[32:35], v7 offset:20480
    s_waitcnt lgkmcnt(7)
    v_mfma_f32_32x32x16_bf16 v[48:63], v[36:39], v[164:167], v[48:63]
    ds_read_b128 v[36:39], v7 offset:21504
    s_waitcnt lgkmcnt(7)
    v_mfma_f32_32x32x16_bf16 v[48:63], v[40:43], v[168:171], v[48:63]
    ds_read_b128 v[40:43], v7 offset:22528
    s_waitcnt lgkmcnt(7)
    v_mfma_f32_32x32x16_bf16 v[48:63], v[44:47], v[172:175], v[48:63]
    ds_read_b128 v[44:47], v7 offset:23552
    s_waitcnt lgkmcnt(7)
    v_mfma_f32_32x32x16_bf16 v[48:63], v[16:19], v[176:179], v[48:63]
    ds_read_b128 v[16:19], v7 offset:24576
    s_waitcnt lgkmcnt(7)
    v_mfma_f32_32x32x16_bf16 v[48:63], v[20:23], v[180:183], v[48:63]
    ds_read_b32 v244, v242 offset:0
    ds_read_b128 v[20:23], v7 offset:25600
    s_waitcnt lgkmcnt(7)
    v_mfma_f32_32x32x16_bf16 v[48:63], v[24:27], v[184:187], v[48:63]
    ds_read_b128 v[24:27], v7 offset:26624
    s_waitcnt lgkmcnt(7)
    v_mfma_f32_32x32x16_bf16 v[48:63], v[28:31], v[188:191], v[48:63]
    ds_read_b128 v[28:31], v7 offset:27648
    s_waitcnt lgkmcnt(7)
    v_mfma_f32_32x32x16_bf16 v[48:63], v[32:35], v[192:195], v[48:63]
    s_waitcnt lgkmcnt(3)
    v_readfirstlane_b32 s71, v244
    s_nop 0
    s_cmp_ge_u32 s71, 4
    s_cbranch_scc1 L_pk_36
    s_mov_b32 s70, 0
L_lw_37:
    ds_read_b32 v244, v242 offset:0
    s_waitcnt lgkmcnt(0)
    v_readfirstlane_b32 s71, v244
    s_nop 0
    s_cmp_ge_u32 s71, 4
    s_cbranch_scc1 L_lwd_38
    s_add_u32 s70, s70, 1
    s_cmp_lt_u32 s70, 800000
    s_cbranch_scc1 L_lw_37
L_lwd_38:
L_pk_36:
    ds_read_b128 v[224:227], v241 offset:0
    s_waitcnt lgkmcnt(7)
    v_mfma_f32_32x32x16_bf16 v[48:63], v[36:39], v[196:199], v[48:63]
    ds_read_b128 v[228:231], v241 offset:1024
    s_waitcnt lgkmcnt(7)
    v_mfma_f32_32x32x16_bf16 v[48:63], v[40:43], v[200:203], v[48:63]
    ds_read_b128 v[232:235], v241 offset:2048
    s_waitcnt lgkmcnt(7)
    v_mfma_f32_32x32x16_bf16 v[48:63], v[44:47], v[204:207], v[48:63]
    ds_read_b128 v[236:239], v241 offset:3072
    s_waitcnt lgkmcnt(7)
    v_mfma_f32_32x32x16_bf16 v[48:63], v[16:19], v[208:211], v[48:63]
    s_waitcnt lgkmcnt(6)
    v_mfma_f32_32x32x16_bf16 v[48:63], v[20:23], v[212:215], v[48:63]
    s_waitcnt lgkmcnt(5)
    v_mfma_f32_32x32x16_bf16 v[48:63], v[24:27], v[216:219], v[48:63]
    s_waitcnt lgkmcnt(4)
    v_mfma_f32_32x32x16_bf16 v[48:63], v[28:31], v[220:223], v[48:63]
    s_waitcnt vmcnt(0)
    s_nop 4
    s_waitcnt lgkmcnt(3)
    v_mfma_f32_32x32x16_bf16 v[64:79], v[224:227], v[112:115], 0
    ds_read_b128 v[224:227], v241 offset:4096
    s_nop 2
    v_cvt_pk_bf16_f32 v88, v48, v49
    v_cvt_pk_bf16_f32 v89, v50, v51
    s_waitcnt lgkmcnt(3)
    v_mfma_f32_32x32x16_bf16 v[64:79], v[228:231], v[116:119], v[64:79]
    ds_read_b128 v[228:231], v241 offset:5120
    v_cvt_pk_bf16_f32 v90, v52, v53
    v_cvt_pk_bf16_f32 v91, v54, v55
    v_cvt_pk_bf16_f32 v92, v56, v57
    v_cvt_pk_bf16_f32 v93, v58, v59
    v_cvt_pk_bf16_f32 v94, v60, v61
    s_waitcnt lgkmcnt(3)
    v_mfma_f32_32x32x16_bf16 v[64:79], v[232:235], v[120:123], v[64:79]
    ds_read_b128 v[232:235], v241 offset:6144
    v_cvt_pk_bf16_f32 v95, v62, v63
    v_mfma_f32_32x32x16_bf16 v[96:111], v[80:83], v[88:91], 0
    s_waitcnt lgkmcnt(3)
    v_mfma_f32_32x32x16_bf16 v[64:79], v[236:239], v[124:127], v[64:79]
    ds_read_b128 v[236:239], v241 offset:7168
    v_mfma_f32_32x32x16_bf16 v[96:111], v[84:87], v[92:95], v[96:111]
    v_cndmask_b32 v48, 0, 1.0, s[66:67]
    v_cndmask_b32 v49, 0, 1.0, s[66:67]
    v_cndmask_b32 v50, 0, 1.0, s[66:67]
    v_cndmask_b32 v51, 0, 1.0, s[66:67]
    v_cndmask_b32 v52, 0, 1.0, s[66:67]
    s_waitcnt lgkmcnt(3)
    v_mfma_f32_32x32x16_bf16 v[64:79], v[224:227], v[128:131], v[64:79]
    ds_read_b128 v[224:227], v241 offset:8192
    v_cndmask_b32 v53, 0, 1.0, s[66:67]
    v_cndmask_b32 v54, 0, 1.0, s[66:67]
    v_cndmask_b32 v55, 0, 1.0, s[66:67]
    v_cndmask_b32 v56, 0, 1.0, s[66:67]
    v_cndmask_b32 v57, 0, 1.0, s[66:67]
    s_waitcnt lgkmcnt(3)
    v_mfma_f32_32x32x16_bf16 v[64:79], v[228:231], v[132:135], v[64:79]
    ds_read_b128 v[228:231], v241 offset:9216
    v_cndmask_b32 v58, 0, 1.0, s[66:67]
    v_cndmask_b32 v59, 0, 1.0, s[66:67]
    v_cndmask_b32 v60, 0, 1.0, s[66:67]
    v_cndmask_b32 v61, 0, 1.0, s[66:67]
    v_cndmask_b32 v62, 0, 1.0, s[66:67]
    s_waitcnt lgkmcnt(3)
    v_mfma_f32_32x32x16_bf16 v[64:79], v[232:235], v[136:139], v[64:79]
    ds_read_b128 v[232:235], v241 offset:10240
    v_cndmask_b32 v63, 0, 1.0, s[66:67]
    v_max_f32 v10, v96, v97
    v_max_f32_e64 v12, -v96, -v97
    v_max3_f32 v10, v10, v98, v99
    v_max3_f32 v12, v12, -v98, -v99
    s_waitcnt lgkmcnt(3)
    v_mfma_f32_32x32x16_bf16 v[64:79], v[236:239], v[140:143], v[64:79]
    ds_read_b128 v[236:239], v241 offset:11264
    v_max3_f32 v10, v10, v100, v101
    v_max3_f32 v12, v12, -v100, -v101
    v_max3_f32 v10, v10, v102, v104
    v_max3_f32 v12, v12, -v102, -v104
    v_max3_f32 v10, v10, v105, v106
    s_waitcnt lgkmcnt(3)
    v_mfma_f32_32x32x16_bf16 v[64:79], v[224:227], v[144:147], v[64:79]
    ds_read_b128 v[224:227], v241 offset:12288
    v_max3_f32 v12, v12, -v105, -v106
    v_max3_f32 v10, v10, v107, v108
    v_max3_f32 v12, v12, -v107, -v108
    v_max3_f32 v10, v10, v109, v110
    v_max3_f32 v12, v12, -v109, -v110
    s_waitcnt lgkmcnt(3)
    v_mfma_f32_32x32x16_bf16 v[64:79], v[228:231], v[148:151], v[64:79]
    ds_read_b128 v[228:231], v241 offset:13312
    v_permlane32_swap_b32 v10, v12
    v_max_f32 v10, v10, v12
    v_mul_f32 v10, s74, v10
    v_mov_b32 v12, v10
    s_nop 0
    s_waitcnt lgkmcnt(3)
    v_mfma_f32_32x32x16_bf16 v[64:79], v[232:235], v[152:155], v[64:79]
    ds_read_b128 v[232:235], v241 offset:14336
    v_permlane32_swap_b32 v10, v12
    v_fma_f32 v16, v96, s72, v10
    v_fma_f32 v17, v97, s73, v10
    v_fma_f32 v18, v98, s72, v10
    v_fma_f32 v19, v99, s73, v10
    s_waitcnt lgkmcnt(3)
    v_mfma_f32_32x32x16_bf16 v[64:79], v[236:239], v[156:159], v[64:79]
    ds_read_b128 v[236:239], v241 offset:15360
    v_fma_f32 v20, v100, s72, v10
    v_fma_f32 v21, v101, s73, v10
    v_fma_f32 v22, v102, s72, v10
    v_fma_f32 v24, v104, s72, v10
    v_fma_f32 v25, v105, s73, v10
    s_waitcnt lgkmcnt(3)
    v_mfma_f32_32x32x16_bf16 v[64:79], v[224:227], v[160:163], v[64:79]
    ds_read_b128 v[224:227], v241 offset:16384
    v_fma_f32 v26, v106, s72, v10
    v_fma_f32 v27, v107, s73, v10
    v_fma_f32 v28, v108, s72, v10
    v_fma_f32 v29, v109, s73, v10
    v_fma_f32 v30, v110, s72, v10
    s_waitcnt lgkmcnt(3)
    v_mfma_f32_32x32x16_bf16 v[64:79], v[228:231], v[164:167], v[64:79]
    ds_read_b128 v[228:231], v241 offset:17408
    v_fma_f32 v32, v96, s74, v12
    v_fma_f32 v33, v97, s75, v12
    v_fma_f32 v34, v98, s74, v12
    v_fma_f32 v35, v99, s75, v12
    v_fma_f32 v36, v100, s74, v12
    s_waitcnt lgkmcnt(3)
    v_mfma_f32_32x32x16_bf16 v[64:79], v[232:235], v[168:171], v[64:79]
    ds_read_b128 v[232:235], v241 offset:18432
    v_fma_f32 v37, v101, s75, v12
    v_fma_f32 v38, v102, s74, v12
    v_fma_f32 v40, v104, s74, v12
    v_fma_f32 v41, v105, s75, v12
    v_fma_f32 v42, v106, s74, v12
    s_waitcnt lgkmcnt(3)
    v_mfma_f32_32x32x16_bf16 v[64:79], v[236:239], v[172:175], v[64:79]
    ds_read_b128 v[236:239], v241 offset:19456
    v_fma_f32 v43, v107, s75, v12
    v_fma_f32 v44, v108, s74, v12
    v_fma_f32 v45, v109, s75, v12
    v_fma_f32 v46, v110, s74, v12
    v_exp_f32 v16, v16
    s_waitcnt lgkmcnt(3)
    v_mfma_f32_32x32x16_bf16 v[64:79], v[224:227], v[176:179], v[64:79]
    ds_read_b128 v[224:227], v241 offset:20480
    v_exp_f32 v17, v17
    v_exp_f32 v18, v18
    v_exp_f32 v19, v19
    s_waitcnt lgkmcnt(3)
    v_mfma_f32_32x32x16_bf16 v[64:79], v[228:231], v[180:183], v[64:79]
    ds_read_b128 v[228:231], v241 offset:21504
    v_exp_f32 v20, v20
    v_exp_f32 v21, v21
    v_exp_f32 v22, v22
    s_waitcnt lgkmcnt(3)
    v_mfma_f32_32x32x16_bf16 v[64:79], v[232:235], v[184:187], v[64:79]
    ds_read_b128 v[232:235], v241 offset:22528
    v_mov_b32 v23, 0
    v_exp_f32 v24, v24
    v_exp_f32 v25, v25
    s_waitcnt lgkmcnt(3)
    v_mfma_f32_32x32x16_bf16 v[64:79], v[236:239], v[188:191], v[64:79]
    ds_read_b64 v[244:245], v242 offset:16
    ds_read_b128 v[236:239], v241 offset:23552
    v_exp_f32 v26, v26
    v_exp_f32 v27, v27
    v_exp_f32 v28, v28
    s_waitcnt lgkmcnt(3)
    v_mfma_f32_32x32x16_bf16 v[64:79], v[224:227], v[192:195], v[64:79]
    ds_read_b128 v[224:227], v241 offset:24576
    v_exp_f32 v29, v29
    v_exp_f32 v30, v30
    v_mov_b32 v31, 0
    s_waitcnt lgkmcnt(3)
    v_mfma_f32_32x32x16_bf16 v[64:79], v[228:231], v[196:199], v[64:79]
    ds_read_b128 v[228:231], v241 offset:25600
    v_exp_f32 v32, v32
    v_exp_f32 v33, v33
    v_exp_f32 v34, v34
    s_waitcnt lgkmcnt(3)
    v_mfma_f32_32x32x16_bf16 v[64:79], v[232:235], v[200:203], v[64:79]
    s_waitcnt lgkmcnt(3)
    v_readfirstlane_b32 s71, v244
    s_nop 0
    s_cmp_ge_u32 s71, 4
    s_cbranch_scc1 L_pk_39
    s_mov_b32 s70, 0
L_lw_40:
    ds_read_b64 v[244:245], v242 offset:16
    s_waitcnt lgkmcnt(0)
    v_readfirstlane_b32 s71, v244
    s_nop 0
    s_cmp_ge_u32 s71, 4
    s_cbranch_scc1 L_lwd_41
    s_add_u32 s70, s70, 1
    s_cmp_lt_u32 s70, 800000
    s_cbranch_scc1 L_lw_40
L_lwd_41:
L_pk_39:
    v_mul_f32 v245, 0x3f840800, v245
    ds_read_b128 v[232:235], v241 offset:26624
    v_exp_f32 v35, v35
    v_exp_f32 v36, v36
    v_exp_f32 v37, v37
    s_waitcnt lgkmcnt(3)
    v_mfma_f32_32x32x16_bf16 v[64:79], v[236:239], v[204:207], v[64:79]
    ds_read_b128 v[236:239], v241 offset:27648
    v_exp_f32 v38, v38
    v_mov_b32 v39, 0
    v_exp_f32 v40, v40
    s_waitcnt lgkmcnt(3)
    v_mfma_f32_32x32x16_bf16 v[64:79], v[224:227], v[208:211], v[64:79]
    v_exp_f32 v41, v41
    v_exp_f32 v42, v42
    v_exp_f32 v43, v43
    s_waitcnt lgkmcnt(2)
    v_mfma_f32_32x32x16_bf16 v[64:79], v[228:231], v[212:215], v[64:79]
    v_exp_f32 v44, v44
    v_exp_f32 v45, v45
    v_exp_f32 v46, v46
    s_waitcnt lgkmcnt(1)
    v_mfma_f32_32x32x16_bf16 v[64:79], v[232:235], v[216:219], v[64:79]
    v_mov_b32 v47, 0
    v_add_f32 v96, v16, v18
    v_add_f32 v97, v17, v19
    v_add_f32 v98, v20, v22
    v_add_f32 v99, v21, v23
    s_waitcnt lgkmcnt(0)
    v_mfma_f32_32x32x16_bf16 v[64:79], v[236:239], v[220:223], v[64:79]
    v_add_f32 v100, v24, v26
    v_add_f32 v101, v25, v27
    v_add_f32 v102, v28, v30
    v_add_f32 v103, v29, v31
    v_add_f32 v104, v32, v34
    v_add_f32 v105, v33, v35
    v_add_f32 v106, v36, v38
    v_add_f32 v107, v37, v39
    v_add_f32 v108, v40, v42
    v_add_f32 v109, v41, v43
    v_add_f32 v110, v44, v46
    v_add_f32 v111, v45, v47
    v_add_f32 v96, v96, v98
    v_add_f32 v97, v97, v99
    v_add_f32 v100, v100, v102
    v_cvt_pk_bf16_f32 v88, v64, v65
    v_cvt_pk_bf16_f32 v89, v66, v67
    v_cvt_pk_bf16_f32 v90, v68, v69
    v_cvt_pk_bf16_f32 v91, v70, v71
    v_cvt_pk_bf16_f32 v92, v72, v73
    v_cvt_pk_bf16_f32 v93, v74, v75
    v_cvt_pk_bf16_f32 v94, v76, v77
    v_cvt_pk_bf16_f32 v95, v78, v79
    v_mov_b32 v224, 0
    v_mov_b32 v225, 0
    ds_write_b128 v4, v[88:91]
    v_dot2_f32_bf16 v224, v88, v88, v224
    v_dot2_f32_bf16 v225, v92, v92, v225
    v_dot2_f32_bf16 v224, v89, v89, v224
    v_dot2_f32_bf16 v225, v93, v93, v225
    v_dot2_f32_bf16 v224, v90, v90, v224
    v_dot2_f32_bf16 v225, v94, v94, v225
    v_dot2_f32_bf16 v224, v91, v91, v224
    v_dot2_f32_bf16 v225, v95, v95, v225
    s_nop 2
    v_add_f32 v224, v224, v225
    v_mov_b32 v225, v224
    s_nop 1
    v_permlane32_swap_b32 v224, v225
    v_add_f32 v224, v224, v225
    v_mul_f32 v224, v224, v245
    v_sqrt_f32 v224, v224
    s_nop 0
    v_sub_f32 v224, 0x42400000, v224
    v_cvt_pk_bf16_f32 v224, v224, 0
    v_cndmask_b32 v94, v94, v224, s[64:65]
    ds_write_b128 v4, v[92:95] offset:1024
    s_mov_b64 exec, 1
    ds_add_u32 v242, v243 offset:60
    s_mov_b64 exec, -1
    v_add_f32 v101, v101, v103
    v_add_f32 v104, v104, v106
    v_add_f32 v105, v105, v107
    v_add_f32 v108, v108, v110
    v_add_f32 v109, v109, v111
    v_add_f32 v96, v96, v100
    v_add_f32 v97, v97, v101
    v_add_f32 v104, v104, v108
    v_add_f32 v105, v105, v109
    v_add_f32 v10, v96, v97
    v_add_f32 v12, v104, v105
    s_nop 1
    v_permlane32_swap_b32 v10, v12
    v_add_f32 v10, v10, v12
    v_rcp_f32 v10, v10
    s_nop 0
    v_mov_b32 v12, v10
    s_nop 1
    v_permlane32_swap_b32 v10, v12
    v_mul_f32 v16, v16, v10
    v_mul_f32 v17, v17, v10
    v_mul_f32 v18, v18, v10
    v_mul_f32 v19, v19, v10
    v_mul_f32 v20, v20, v10
    v_mul_f32 v21, v21, v10
    v_mul_f32 v22, v22, v10
    v_mul_f32 v24, v24, v10
    v_mul_f32 v25, v25, v10
    v_mul_f32 v26, v26, v10
    v_mul_f32 v27, v27, v10
    v_mul_f32 v28, v28, v10
    v_mul_f32 v29, v29, v10
    v_mul_f32 v30, v30, v10
    v_mul_f32 v32, v32, v12
    v_mul_f32 v33, v33, v12
    v_mul_f32 v34, v34, v12
    v_mul_f32 v35, v35, v12
    v_mul_f32 v36, v36, v12
    v_mul_f32 v37, v37, v12
    v_mul_f32 v38, v38, v12
    v_mul_f32 v40, v40, v12
    v_mul_f32 v41, v41, v12
    v_mul_f32 v42, v42, v12
    v_mul_f32 v43, v43, v12
    v_mul_f32 v44, v44, v12
    v_mul_f32 v45, v45, v12
    v_mul_f32 v46, v46, v12
    v_cvt_pk_bf16_f32 v96, v16, v17
    v_cvt_pk_bf16_f32 v97, v18, v19
    v_cvt_pk_bf16_f32 v98, v20, v21
    v_cvt_pk_bf16_f32 v99, v22, v23
    v_cvt_pk_bf16_f32 v100, v24, v25
    v_cvt_pk_bf16_f32 v101, v26, v27
    v_cvt_pk_bf16_f32 v102, v28, v29
    v_cvt_pk_bf16_f32 v103, v30, v31
    v_cvt_pk_bf16_f32 v104, v32, v33
    v_cvt_pk_bf16_f32 v105, v34, v35
    v_cvt_pk_bf16_f32 v106, v36, v37
    v_cvt_pk_bf16_f32 v107, v38, v39
    v_cvt_pk_bf16_f32 v108, v40, v41
    v_cvt_pk_bf16_f32 v109, v42, v43
    v_cvt_pk_bf16_f32 v110, v44, v45
    v_cvt_pk_bf16_f32 v111, v46, v47
    ds_write_b64 v250, v[96:97] offset:0
    ds_write_b64 v250, v[98:99] offset:16
    ds_write_b64 v250, v[100:101] offset:32
    ds_write_b64 v250, v[102:103] offset:48
    ds_write_b64 v250, v[104:105] offset:9216
    ds_write_b64 v250, v[106:107] offset:9232
    ds_write_b64 v250, v[108:109] offset:9248
    ds_write_b64 v250, v[110:111] offset:9264
    s_mov_b32 s70, 0
L_lw_42:
    ds_read_b32 v244, v242 offset:48
    s_waitcnt lgkmcnt(0)
    v_readfirstlane_b32 s71, v244
    s_nop 0
    s_cmp_ge_u32 s71, 4
    s_cbranch_scc1 L_lwd_43
    s_add_u32 s70, s70, 1
    s_cmp_lt_u32 s70, 800000
    s_cbranch_scc1 L_lw_42
L_lwd_43:
    s_setprio 0
    ds_read_b128 v[224:227], v241 offset:28672
    ds_read_b128 v[228:231], v241 offset:29696
    ds_read_b128 v[232:235], v241 offset:30720
    ds_read_b128 v[236:239], v241 offset:31744
    s_waitcnt lgkmcnt(3)
    v_mfma_f32_32x32x16_bf16 v[48:63], v[112:115], v[224:227], v[48:63]
    s_lshr_b32 s8, s2, 3
    s_and_b32 s57, s8, 15
    s_lshl_b32 s57, s57, 2
    s_add_u32 s57, s57, s7
    s_mul_i32 s57, s57, 6272
    s_bitcmp1_b32 s8, 4
    s_cselect_b32 s52, s32, s60
    s_cselect_b32 s53, s33, s61
    s_mov_b32 s54, 401408
    s_mov_b32 s55, 0x00020000
    s_mov_b32 exec_hi, 0x1ffff
    buffer_load_dword v4, v1, s[52:55], s57 offen
    s_mov_b64 exec, -1
    ds_read_b128 v[224:227], v241 offset:32768
    s_waitcnt lgkmcnt(3)
    v_mfma_f32_32x32x16_bf16 v[48:63], v[116:119], v[228:231], v[48:63]
    ds_read_b128 v[228:231], v241 offset:33792
    s_waitcnt lgkmcnt(3)
    v_mfma_f32_32x32x16_bf16 v[48:63], v[120:123], v[232:235], v[48:63]
    ds_read_b128 v[232:235], v241 offset:34816
    s_waitcnt lgkmcnt(3)
    v_mfma_f32_32x32x16_bf16 v[48:63], v[124:127], v[236:239], v[48:63]
    ds_read_b128 v[236:239], v241 offset:35840
    s_waitcnt lgkmcnt(3)
    v_mfma_f32_32x32x16_bf16 v[48:63], v[128:131], v[224:227], v[48:63]
    ds_read_b128 v[224:227], v241 offset:36864
    s_waitcnt lgkmcnt(3)
    v_mfma_f32_32x32x16_bf16 v[48:63], v[132:135], v[228:231], v[48:63]
    ds_read_b128 v[228:231], v241 offset:37888
    s_waitcnt lgkmcnt(3)
    v_mfma_f32_32x32x16_bf16 v[48:63], v[136:139], v[232:235], v[48:63]
    ds_read_b128 v[232:235], v241 offset:38912
    s_waitcnt lgkmcnt(3)
    v_mfma_f32_32x32x16_bf16 v[48:63], v[140:143], v[236:239], v[48:63]
    ds_read_b128 v[236:239], v241 offset:39936
    s_waitcnt lgkmcnt(3)
    v_mfma_f32_32x32x16_bf16 v[48:63], v[144:147], v[224:227], v[48:63]
    ds_read_b128 v[224:227], v241 offset:40960
    s_waitcnt lgkmcnt(3)
    v_mfma_f32_32x32x16_bf16 v[48:63], v[148:151], v[228:231], v[48:63]
    ds_read_b128 v[228:231], v241 offset:41984
    s_waitcnt lgkmcnt(3)
    v_mfma_f32_32x32x16_bf16 v[48:63], v[152:155], v[232:235], v[48:63]
    ds_read_b128 v[232:235], v241 offset:43008
    s_waitcnt lgkmcnt(3)
    v_mfma_f32_32x32x16_bf16 v[48:63], v[156:159], v[236:239], v[48:63]
    s_mov_b32 s70, 0
L_lw_44:
    ds_read_b32 v244, v242 offset:60
    s_waitcnt lgkmcnt(0)
    v_readfirstlane_b32 s71, v244
    s_nop 0
    s_cmp_ge_u32 s71, 4
    s_cbranch_scc1 L_lwd_45
    s_sleep 1
    s_add_u32 s70, s70, 1
    s_cmp_lt_u32 s70, 800000
    s_cbranch_scc1 L_lw_44
L_lwd_45:
    ds_read_b128 v[236:239], v241 offset:44032
    s_waitcnt lgkmcnt(3)
    v_mfma_f32_32x32x16_bf16 v[48:63], v[160:163], v[224:227], v[48:63]
    s_mov_b32 s52, s60
    s_mov_b32 s53, s61
    s_mov_b32 s54, 401408
    s_mov_b32 s55, 0x00020000
    s_mul_i32 s62, s7, 100352
    s_lshl_b32 s63, s78, 7
    s_add_u32 s62, s62, s63
    s_mov_b32 s63, s56
    ds_read_b128 v[224:227], v241 offset:45056
    s_waitcnt lgkmcnt(3)
    v_mfma_f32_32x32x16_bf16 v[48:63], v[164:167], v[228:231], v[48:63]
    s_mov_b32 m0, s63
    s_addk_i32 s63, 1024
    buffer_load_dwordx4 v247, s[52:55], s62 offen lds
    s_addk_i32 s62, 7168
    ds_read_b128 v[228:231], v241 offset:46080
    s_waitcnt lgkmcnt(3)
    v_mfma_f32_32x32x16_bf16 v[48:63], v[168:171], v[232:235], v[48:63]
    s_mov_b32 m0, s63
    s_addk_i32 s63, 1024
    buffer_load_dwordx4 v247, s[52:55], s62 offen lds
    s_addk_i32 s62, 7168
    ds_read_b128 v[232:235], v241 offset:47104
    s_waitcnt lgkmcnt(3)
    v_mfma_f32_32x32x16_bf16 v[48:63], v[172:175], v[236:239], v[48:63]
    s_mov_b32 m0, s63
    s_addk_i32 s63, 1024
    buffer_load_dwordx4 v247, s[52:55], s62 offen lds
    s_addk_i32 s62, 7168
    ds_read_b128 v[236:239], v241 offset:48128
    s_waitcnt lgkmcnt(3)
    v_mfma_f32_32x32x16_bf16 v[48:63], v[176:179], v[224:227], v[48:63]
    s_mov_b32 m0, s63
    s_addk_i32 s63, 1024
    buffer_load_dwordx4 v247, s[52:55], s62 offen lds
    s_addk_i32 s62, 7168
    ds_read_b128 v[224:227], v241 offset:49152
    s_waitcnt lgkmcnt(3)
    v_mfma_f32_32x32x16_bf16 v[48:63], v[180:183], v[228:231], v[48:63]
    s_mov_b32 m0, s63
    s_addk_i32 s63, 1024
    buffer_load_dwordx4 v247, s[52:55], s62 offen lds
    s_addk_i32 s62, 7168
    ds_read_b128 v[228:231], v241 offset:50176
    s_waitcnt lgkmcnt(3)
    v_mfma_f32_32x32x16_bf16 v[48:63], v[184:187], v[232:235], v[48:63]
    s_mov_b32 m0, s63
    s_addk_i32 s63, 1024
    buffer_load_dwordx4 v247, s[52:55], s62 offen lds
    s_addk_i32 s62, 7168
    ds_read_b128 v[232:235], v241 offset:51200
    s_waitcnt lgkmcnt(3)
    v_mfma_f32_32x32x16_bf16 v[48:63], v[188:191], v[236:239], v[48:63]
    s_mov_b32 m0, s63
    s_addk_i32 s63, 1024
    buffer_load_dwordx4 v247, s[52:55], s62 offen lds
    s_addk_i32 s62, 7168
    ds_read_b128 v[236:239], v241 offset:52224
    s_waitcnt lgkmcnt(3)
    v_mfma_f32_32x32x16_bf16 v[48:63], v[192:195], v[224:227], v[48:63]
    s_mov_b32 m0, s63
    s_addk_i32 s63, 1024
    buffer_load_dwordx4 v247, s[52:55], s62 offen lds
    s_addk_i32 s62, 7168
    ds_read_b128 v[224:227], v241 offset:53248
    s_waitcnt lgkmcnt(3)
    v_mfma_f32_32x32x16_bf16 v[48:63], v[196:199], v[228:231], v[48:63]
    s_mov_b32 m0, s63
    s_addk_i32 s63, 1024
    buffer_load_dwordx4 v247, s[52:55], s62 offen lds
    s_addk_i32 s62, 7168
    ds_read_b128 v[228:231], v241 offset:54272
    s_waitcnt lgkmcnt(3)
    v_mfma_f32_32x32x16_bf16 v[48:63], v[200:203], v[232:235], v[48:63]
    s_mov_b32 m0, s63
    s_addk_i32 s63, 1024
    buffer_load_dwordx4 v247, s[52:55], s62 offen lds
    s_addk_i32 s62, 7168
    ds_read_b128 v[232:235], v241 offset:55296
    s_waitcnt lgkmcnt(3)
    v_mfma_f32_32x32x16_bf16 v[48:63], v[204:207], v[236:239], v[48:63]
    s_mov_b32 m0, s63
    s_addk_i32 s63, 1024
    buffer_load_dwordx4 v247, s[52:55], s62 offen lds
    s_addk_i32 s62, 7168
    ds_read_b128 v[236:239], v241 offset:56320
    s_waitcnt lgkmcnt(3)
    v_mfma_f32_32x32x16_bf16 v[48:63], v[208:211], v[224:227], v[48:63]
    s_mov_b32 m0, s63
    s_addk_i32 s63, 1024
    buffer_load_dwordx4 v247, s[52:55], s62 offen lds
    s_addk_i32 s62, 7168
    s_waitcnt lgkmcnt(2)
    v_mfma_f32_32x32x16_bf16 v[48:63], v[212:215], v[228:231], v[48:63]
    s_mov_b32 m0, s63
    s_addk_i32 s63, 1024
    buffer_load_dwordx4 v247, s[52:55], s62 offen lds
    s_addk_i32 s62, 7168
    s_waitcnt lgkmcnt(1)
    v_mfma_f32_32x32x16_bf16 v[48:63], v[216:219], v[232:235], v[48:63]
    s_mov_b32 m0, s63
    s_addk_i32 s63, 1024
    buffer_load_dwordx4 v247, s[52:55], s62 offen lds
    s_addk_i32 s62, 7168
    s_waitcnt lgkmcnt(0)
    v_mfma_f32_32x32x16_bf16 v[48:63], v[220:223], v[236:239], v[48:63]
    s_setprio 2
    s_nop 10
    v_cvt_pk_bf16_f32 v48, v48, v49
    v_cvt_pk_bf16_f32 v49, v50, v51
    v_cvt_pk_bf16_f32 v50, v52, v53
    v_cvt_pk_bf16_f32 v51, v54, v55
    v_cvt_pk_bf16_f32 v52, v56, v57
    v_cvt_pk_bf16_f32 v53, v58, v59
    v_cvt_pk_bf16_f32 v54, v60, v61
    v_cvt_pk_bf16_f32 v55, v62, v63
    ds_write_b128 v3, v[48:51]
    ds_write_b128 v3, v[52:55] offset:1024
    s_mov_b64 exec, 1
    ds_add_u32 v242, v243 offset:8
    s_mov_b64 exec, -1
    s_lshl_b32 s8, s5, 1
    s_add_u32 s8, s8, s7
    s_lshl_b32 s11, s8, 10
    s_lshl_b32 s10, s4, 2
    s_add_u32 s11, s11, s10
    s_add_u32 s11, s11, 917504
    s_lshl_b32 s8, s8, 15
    s_lshl_b32 s9, s4, 8
    s_add_u32 s8, s8, s9
    s_add_u32 s8, s8, 3145728
    s_lshl_b32 s13, s5, 12
    s_add_u32 s13, s13, 2949120
    s_add_u32 s14, s13, s9
    s_add_u32 s9, s8, 16384
    s_lshl_b32 s79, s5, 4
    s_add_u32 s79, s79, s4
    s_lshl_b32 s12, s79, 12
    s_add_u32 s12, s12, 3145728
    s_lshl_b32 s79, s79, 7
    s_add_u32 s59, s79, 950272
    s_add_u32 s79, s79, 917504
    s_lshl_b32 s15, s5, 11
    s_add_u32 s15, s15, s10
    s_add_u32 s15, s15, 950272
    s_add_u32 s38, s39, 0x02000000
    s_mov_b32 s70, 0
L_lw_46:
    ds_read_b32 v244, v242 offset:8
    s_waitcnt lgkmcnt(0)
    v_readfirstlane_b32 s71, v244
    s_nop 0
    s_cmp_ge_u32 s71, 4
    s_cbranch_scc1 L_lwd_47
    s_sleep 1
    s_add_u32 s70, s70, 1
    s_cmp_lt_u32 s70, 800000
    s_cbranch_scc1 L_lw_46
L_lwd_47:
    s_cmp_ge_u32 s7, 2
    s_cbranch_scc1 L_nokvp
    ds_read_b64_tr_b16 v[16:17], v251 offset:0
    ds_read_b64_tr_b16 v[18:19], v251 offset:576
    ds_read_b128 v[20:23], v15 offset:47104
    ds_read_b64_tr_b16 v[24:25], v251 offset:1152
    ds_read_b64_tr_b16 v[26:27], v251 offset:1728
    ds_read_b128 v[28:31], v15 offset:48128
    ds_read_b64_tr_b16 v[32:33], v251 offset:2304
    ds_read_b64_tr_b16 v[34:35], v251 offset:2880
    ds_read_b128 v[36:39], v15 offset:49152
    s_setprio 0
    ds_read_b64_tr_b16 v[40:41], v251 offset:3456
    ds_read_b64_tr_b16 v[42:43], v251 offset:4032
    ds_read_b128 v[44:47], v15 offset:50176
    s_waitcnt lgkmcnt(9)
    v_mfma_f32_32x32x16_bf16 v[48:63], v[16:19], v[20:23], 0
    ds_read_b64_tr_b16 v[16:17], v251 offset:4608
    ds_read_b64_tr_b16 v[18:19], v251 offset:5184
    ds_read_b128 v[20:23], v15 offset:51200
    s_waitcnt lgkmcnt(9)
    v_mfma_f32_32x32x16_bf16 v[48:63], v[24:27], v[28:31], v[48:63]
    ds_read_b64_tr_b16 v[24:25], v251 offset:5760
    ds_read_b64_tr_b16 v[26:27], v251 offset:6336
    ds_read_b128 v[28:31], v15 offset:52224
    s_waitcnt lgkmcnt(9)
    v_mfma_f32_32x32x16_bf16 v[48:63], v[32:35], v[36:39], v[48:63]
    ds_read_b64_tr_b16 v[32:33], v251 offset:6912
    ds_read_b64_tr_b16 v[34:35], v251 offset:7488
    ds_read_b128 v[36:39], v15 offset:53248
    s_waitcnt lgkmcnt(9)
    v_mfma_f32_32x32x16_bf16 v[48:63], v[40:43], v[44:47], v[48:63]
    ds_read_b64_tr_b16 v[40:41], v251 offset:8064
    ds_read_b64_tr_b16 v[42:43], v251 offset:8640
    ds_read_b128 v[44:47], v15 offset:54272
    s_waitcnt lgkmcnt(9)
    v_mfma_f32_32x32x16_bf16 v[48:63], v[16:19], v[20:23], v[48:63]
    s_waitcnt lgkmcnt(6)
    v_mfma_f32_32x32x16_bf16 v[48:63], v[24:27], v[28:31], v[48:63]
    s_waitcnt lgkmcnt(3)
    v_mfma_f32_32x32x16_bf16 v[48:63], v[32:35], v[36:39], v[48:63]
    s_waitcnt lgkmcnt(0)
    v_mfma_f32_32x32x16_bf16 v[48:63], v[40:43], v[44:47], v[48:63]
    s_setprio 2
    s_nop 10
    v_cvt_pk_bf16_f32 v88, v48, v49
    v_cvt_pk_bf16_f32 v89, v50, v51
    v_cvt_pk_bf16_f32 v90, v52, v53
    v_cvt_pk_bf16_f32 v91, v54, s39
    buffer_store_dwordx4 v[88:91], v9, s[48:51], s8 offen sc1
    v_cvt_pk_bf16_f32 v92, v56, v57
    v_cvt_pk_bf16_f32 v93, v58, v59
    v_cvt_pk_bf16_f32 v94, v60, v61
    v_cvt_pk_bf16_f32 v95, v62, s39
    buffer_store_dwordx4 v[92:95], v9, s[48:51], s9 offen offset:0 sc1
    v_lshlrev_b32 v10, 3, v241
    s_mov_b64 exec, 0xff
    buffer_store_dword v248, v10, s[48:51], s11 offen sc1
    s_mov_b64 exec, -1
L_nokvp:
    s_setprio 0
    ds_read_b128 v[16:19], v15 offset:0
    ds_read_b128 v[20:23], v15 offset:1024
    ds_read_b128 v[24:27], v15 offset:2048
    ds_read_b128 v[28:31], v15 offset:3072
    ds_read_b128 v[32:35], v15 offset:4096
    ds_read_b128 v[36:39], v15 offset:5120
    ds_read_b128 v[40:43], v15 offset:6144
    ds_read_b128 v[44:47], v15 offset:7168
    s_waitcnt lgkmcnt(7)
    v_mfma_f32_32x32x16_bf16 v[64:79], v[16:19], v[112:115], 0
    ds_read_b128 v[16:19], v15 offset:8192
    s_waitcnt lgkmcnt(7)
    v_mfma_f32_32x32x16_bf16 v[64:79], v[20:23], v[116:119], v[64:79]
    ds_read_b128 v[20:23], v15 offset:9216
    s_waitcnt lgkmcnt(7)
    v_mfma_f32_32x32x16_bf16 v[64:79], v[24:27], v[120:123], v[64:79]
    ds_read_b128 v[24:27], v15 offset:10240
    s_waitcnt lgkmcnt(7)
    v_mfma_f32_32x32x16_bf16 v[64:79], v[28:31], v[124:127], v[64:79]
    ds_read_b128 v[28:31], v15 offset:11264
    s_waitcnt lgkmcnt(7)
    v_mfma_f32_32x32x16_bf16 v[64:79], v[32:35], v[128:131], v[64:79]
    ds_read_b128 v[32:35], v15 offset:12288
    s_waitcnt lgkmcnt(7)
    v_mfma_f32_32x32x16_bf16 v[64:79], v[36:39], v[132:135], v[64:79]
    ds_read_b128 v[36:39], v15 offset:13312
    s_waitcnt lgkmcnt(7)
    v_mfma_f32_32x32x16_bf16 v[64:79], v[40:43], v[136:139], v[64:79]
    ds_read_b128 v[40:43], v15 offset:14336
    s_waitcnt lgkmcnt(7)
    v_mfma_f32_32x32x16_bf16 v[64:79], v[44:47], v[140:143], v[64:79]
    ds_read_b128 v[44:47], v15 offset:15360
    s_waitcnt lgkmcnt(7)
    v_mfma_f32_32x32x16_bf16 v[64:79], v[16:19], v[144:147], v[64:79]
    ds_read_b128 v[16:19], v15 offset:16384
    s_waitcnt lgkmcnt(7)
    v_mfma_f32_32x32x16_bf16 v[64:79], v[20:23], v[148:151], v[64:79]
    ds_read_b128 v[20:23], v15 offset:17408
    s_waitcnt lgkmcnt(7)
    v_mfma_f32_32x32x16_bf16 v[64:79], v[24:27], v[152:155], v[64:79]
    ds_read_b128 v[24:27], v15 offset:18432
    s_waitcnt lgkmcnt(7)
    v_mfma_f32_32x32x16_bf16 v[64:79], v[28:31], v[156:159], v[64:79]
    ds_read_b128 v[28:31], v15 offset:19456
    s_waitcnt lgkmcnt(7)
    v_mfma_f32_32x32x16_bf16 v[64:79], v[32:35], v[160:163], v[64:79]
    s_cmp_lg_u32 s7, 3
    s_cbranch_scc1 L_n3_48
    s_load_dwordx16 s[16:31], s[40:41], s79 glc
L_n3_48:
    ds_read_b128 v[32:35], v15 offset:20480
    s_waitcnt lgkmcnt(7)
    v_mfma_f32_32x32x16_bf16 v[64:79], v[36:39], v[164:167], v[64:79]
    ds_read_b128 v[36:39], v15 offset:21504
    s_waitcnt lgkmcnt(7)
    v_mfma_f32_32x32x16_bf16 v[64:79], v[40:43], v[168:171], v[64:79]
    ds_read_b128 v[40:43], v15 offset:22528
    s_waitcnt lgkmcnt(7)
    v_mfma_f32_32x32x16_bf16 v[64:79], v[44:47], v[172:175], v[64:79]
    ds_read_b128 v[44:47], v15 offset:23552
    s_waitcnt lgkmcnt(7)
    v_mfma_f32_32x32x16_bf16 v[64:79], v[16:19], v[176:179], v[64:79]
    ds_read_b128 v[16:19], v15 offset:24576
    s_waitcnt lgkmcnt(7)
    v_mfma_f32_32x32x16_bf16 v[64:79], v[20:23], v[180:183], v[64:79]
    s_cmp_lg_u32 s7, 3
    s_cbranch_scc1 L_n3_49
    s_mov_b32 s70, 0
    s_branch L_spc_52
L_sp_50:
    s_load_dwordx16 s[16:31], s[40:41], s79 glc
L_spc_52:
    s_waitcnt lgkmcnt(0)
    s_xor_b64 s[16:17], s[16:17], s[34:35]
    s_xor_b64 s[18:19], s[18:19], s[34:35]
    s_xor_b64 s[20:21], s[20:21], s[34:35]
    s_xor_b64 s[22:23], s[22:23], s[34:35]
    s_xor_b64 s[24:25], s[24:25], s[34:35]
    s_xor_b64 s[26:27], s[26:27], s[34:35]
    s_xor_b64 s[28:29], s[28:29], s[34:35]
    s_xor_b64 s[30:31], s[30:31], s[34:35]
    s_or_b64 s[16:17], s[16:17], s[18:19]
    s_or_b64 s[16:17], s[16:17], s[20:21]
    s_or_b64 s[16:17], s[16:17], s[22:23]
    s_or_b64 s[16:17], s[16:17], s[24:25]
    s_or_b64 s[16:17], s[16:17], s[26:27]
    s_or_b64 s[16:17], s[16:17], s[28:29]
    s_or_b64 s[16:17], s[16:17], s[30:31]
    s_cbranch_scc0 L_spd_51
    s_sleep 2
    s_add_u32 s70, s70, 1
    s_cmp_lt_u32 s70, 100000
    s_cbranch_scc1 L_sp_50
L_spd_51:
    buffer_load_dwordx4 v[96:99], v241, s[48:51], s12 offen offset:0 sc1
    buffer_load_dwordx4 v[100:103], v241, s[48:51], s12 offen offset:1024 sc1
    buffer_load_dwordx4 v[104:107], v241, s[48:51], s12 offen offset:2048 sc1
    buffer_load_dwordx4 v[108:111], v241, s[48:51], s12 offen offset:3072 sc1
L_n3_49:
    ds_read_b128 v[20:23], v15 offset:25600
    s_waitcnt lgkmcnt(7)
    v_mfma_f32_32x32x16_bf16 v[64:79], v[24:27], v[184:187], v[64:79]
    ds_read_b128 v[24:27], v15 offset:26624
    s_waitcnt lgkmcnt(7)
    v_mfma_f32_32x32x16_bf16 v[64:79], v[28:31], v[188:191], v[64:79]
    ds_read_b128 v[28:31], v15 offset:27648
    s_waitcnt lgkmcnt(7)
    v_mfma_f32_32x32x16_bf16 v[64:79], v[32:35], v[192:195], v[64:79]
    s_waitcnt lgkmcnt(6)
    v_mfma_f32_32x32x16_bf16 v[64:79], v[36:39], v[196:199], v[64:79]
    s_waitcnt lgkmcnt(5)
    v_mfma_f32_32x32x16_bf16 v[64:79], v[40:43], v[200:203], v[64:79]
    s_waitcnt lgkmcnt(4)
    v_mfma_f32_32x32x16_bf16 v[64:79], v[44:47], v[204:207], v[64:79]
    s_waitcnt lgkmcnt(3)
    v_mfma_f32_32x32x16_bf16 v[64:79], v[16:19], v[208:211], v[64:79]
    s_cmp_lg_u32 s7, 3
    s_cbranch_scc1 L_n3_53
    s_setprio 2
    s_mov_b32 s70, 0
L_wkv:
    s_waitcnt vmcnt(0)
    v_mfma_f32_16x16x32_bf16 v[88:91], v[252:255], v[96:99], 0
    v_mfma_f32_16x16x32_bf16 v[88:91], v[252:255], v[100:103], v[88:91]
    v_mfma_f32_16x16x32_bf16 v[88:91], v[252:255], v[104:107], v[88:91]
    v_mfma_f32_16x16x32_bf16 v[88:91], v[252:255], v[108:111], v[88:91]
    s_mov_b32 s16, 0xffff0000
    s_mov_b32 s17, 0
    s_bitcmp1_b32 s4, 0
    s_cselect_b32 s18, 0x8800, 0
    s_mov_b32 s19, 0
    s_or_b32 s20, s39, 0x3f80
    v_mov_b32 v10, s39
    v_mov_b32 v11, s20
    v_mov_b32 v12, 0x3f803f80
    v_cmp_neq_f32 vcc, s38, v91
    v_cndmask_b32 v91, v91, v10, s[16:17]
    v_cvt_pk_bf16_f32 v92, v88, v89
    v_cvt_pk_bf16_f32 v93, v90, v91
    s_and_b64 vcc, vcc, s[16:17]
    s_cbranch_scc1 L_rkv
L_kkv:
    v_mov_b32 v94, v92
    v_mov_b32 v95, v93
    s_nop 0
    v_permlane16_swap_b32 v92, v94
    v_permlane16_swap_b32 v93, v95
    v_cndmask_b32 v92, v92, v12, s[18:19]
    v_cndmask_b32 v93, v93, v12, s[18:19]
    v_cndmask_b32 v94, v94, v12, s[18:19]
    v_cndmask_b32 v95, v95, v11, s[18:19]
    s_mov_b64 exec, 0xffff
    buffer_store_dwordx4 v[92:95], v241, s[48:51], s14 offen sc1
    s_mov_b64 exec, -1
    v_lshlrev_b32 v10, 3, v241
    s_mov_b64 exec, 0xffff
    buffer_store_dword v248, v10, s[48:51], s15 offen sc1
    s_mov_b64 exec, -1
    s_setprio 0
L_n3_53:
    s_waitcnt lgkmcnt(2)
    v_mfma_f32_32x32x16_bf16 v[64:79], v[20:23], v[212:215], v[64:79]
    s_waitcnt lgkmcnt(1)
    v_mfma_f32_32x32x16_bf16 v[64:79], v[24:27], v[216:219], v[64:79]
    s_waitcnt lgkmcnt(0)
    v_mfma_f32_32x32x16_bf16 v[64:79], v[28:31], v[220:223], v[64:79]
    s_setprio 2
    s_waitcnt vmcnt(0)
    s_nop 9
    v_mov_b32 v14, v76
    v_mov_b32 v245, v76
    v_cvt_pk_bf16_f32 v88, v64, v65
    v_cvt_pk_bf16_f32 v89, v66, v67
    v_cvt_pk_bf16_f32 v90, v68, v69
    v_cvt_pk_bf16_f32 v91, v70, v71
    v_cvt_pk_bf16_f32 v92, v72, v73
    v_cvt_pk_bf16_f32 v93, v74, v75
    v_cvt_pk_bf16_f32 v94, v76, v77
    v_cvt_pk_bf16_f32 v95, v78, v79
    v_mfma_f32_32x32x16_bf16 v[96:111], v[80:83], v[88:91], 0
    s_nop 0
    v_mfma_f32_32x32x16_bf16 v[96:111], v[84:87], v[92:95], v[96:111]
    v_permlane32_swap_b32 v14, v245
    v_mul_f32 v245, s74, v245
    ds_read_b64_tr_b16 v[176:177], v2 offset:0
    ds_read_b64_tr_b16 v[178:179], v6 offset:0
    ds_read_b64_tr_b16 v[180:181], v2 offset:64
    ds_read_b64_tr_b16 v[182:183], v6 offset:64
    v_exp_f32 v14, v245
    v_mov_b32 v80, 0
    v_mov_b32 v81, 0
    v_mov_b32 v82, 0
    v_mov_b32 v83, 0
    ds_read_b64_tr_b16 v[184:185], v2 offset:1792
    ds_read_b64_tr_b16 v[186:187], v6 offset:1792
    ds_read_b64_tr_b16 v[188:189], v2 offset:1856
    ds_read_b64_tr_b16 v[190:191], v6 offset:1856
    s_waitcnt lgkmcnt(4)
    v_add_f32 v14, 1.0, v14
    v_rcp_f32 v14, v14
    v_mfma_f32_32x32x16_bf16 v[64:79], v[80:83], v[80:83], 0
    v_sub_f32 v245, 1.0, v14
    v_mfma_f32_32x32x16_bf16 v[128:143], v[80:83], v[80:83], 0
    ds_write_b32 v5, v245 offset:512
    ds_read_b64_tr_b16 v[192:193], v2 offset:3584
    ds_read_b64_tr_b16 v[194:195], v6 offset:3584
    ds_read_b64_tr_b16 v[196:197], v2 offset:3648
    ds_read_b64_tr_b16 v[198:199], v6 offset:3648
    v_max_f32 v10, v96, v97
    v_max_f32_e64 v12, -v96, -v97
    v_max3_f32 v10, v10, v98, v99
    v_max3_f32 v12, v12, -v98, -v99
    v_max3_f32 v10, v10, v100, v101
    v_max3_f32 v12, v12, -v100, -v101
    ds_read_b64_tr_b16 v[200:201], v2 offset:5376
    ds_read_b64_tr_b16 v[202:203], v6 offset:5376
    ds_read_b64_tr_b16 v[204:205], v2 offset:5440
    ds_read_b64_tr_b16 v[206:207], v6 offset:5440
    s_waitcnt lgkmcnt(4)
    v_max3_f32 v10, v10, v102, v104
    v_max3_f32 v12, v12, -v102, -v104
    v_max3_f32 v10, v10, v105, v106
    v_max3_f32 v12, v12, -v105, -v106
    v_max3_f32 v10, v10, v107, v108
    v_max3_f32 v12, v12, -v107, -v108
    ds_read_b64_tr_b16 v[208:209], v2 offset:7168
    ds_read_b64_tr_b16 v[210:211], v6 offset:7168
    ds_read_b64_tr_b16 v[212:213], v2 offset:7232
    ds_read_b64_tr_b16 v[214:215], v6 offset:7232
    v_max3_f32 v10, v10, v109, v110
    v_max3_f32 v12, v12, -v109, -v110
    s_nop 1
    v_permlane32_swap_b32 v10, v12
    v_max_f32 v10, v10, v12
    v_mul_f32 v10, s74, v10
    ds_read_b64_tr_b16 v[216:217], v2 offset:8960
    ds_read_b64_tr_b16 v[218:219], v6 offset:8960
    ds_read_b64_tr_b16 v[220:221], v2 offset:9024
    ds_read_b64_tr_b16 v[222:223], v6 offset:9024
    s_waitcnt lgkmcnt(4)
    v_mov_b32 v12, v10
    s_nop 1
    v_permlane32_swap_b32 v10, v12
    v_pk_fma_f32 v[16:17], v[96:97], s[72:73], v[10:11] op_sel_hi:[1,1,0]
    v_pk_fma_f32 v[18:19], v[98:99], s[72:73], v[10:11] op_sel_hi:[1,1,0]
    v_pk_fma_f32 v[20:21], v[100:101], s[72:73], v[10:11] op_sel_hi:[1,1,0]
    v_pk_fma_f32 v[22:23], v[102:103], s[72:73], v[10:11] op_sel_hi:[1,1,0]
    ds_read_b64_tr_b16 v[224:225], v2 offset:10752
    ds_read_b64_tr_b16 v[226:227], v6 offset:10752
    ds_read_b64_tr_b16 v[228:229], v2 offset:10816
    ds_read_b64_tr_b16 v[230:231], v6 offset:10816
    v_pk_fma_f32 v[24:25], v[104:105], s[72:73], v[10:11] op_sel_hi:[1,1,0]
    v_pk_fma_f32 v[26:27], v[106:107], s[72:73], v[10:11] op_sel_hi:[1,1,0]
    v_pk_fma_f32 v[28:29], v[108:109], s[72:73], v[10:11] op_sel_hi:[1,1,0]
    v_pk_fma_f32 v[30:31], v[110:111], s[72:73], v[10:11] op_sel_hi:[1,1,0]
    v_pk_fma_f32 v[32:33], v[96:97], s[74:75], v[12:13] op_sel_hi:[1,1,0]
    v_pk_fma_f32 v[34:35], v[98:99], s[74:75], v[12:13] op_sel_hi:[1,1,0]
    ds_read_b64_tr_b16 v[232:233], v2 offset:12544
    ds_read_b64_tr_b16 v[234:235], v6 offset:12544
    ds_read_b64_tr_b16 v[236:237], v2 offset:12608
    ds_read_b64_tr_b16 v[238:239], v6 offset:12608
    s_waitcnt lgkmcnt(4)
    v_pk_fma_f32 v[36:37], v[100:101], s[74:75], v[12:13] op_sel_hi:[1,1,0]
    v_pk_fma_f32 v[38:39], v[102:103], s[74:75], v[12:13] op_sel_hi:[1,1,0]
    v_pk_fma_f32 v[40:41], v[104:105], s[74:75], v[12:13] op_sel_hi:[1,1,0]
    v_pk_fma_f32 v[42:43], v[106:107], s[74:75], v[12:13] op_sel_hi:[1,1,0]
    v_pk_fma_f32 v[44:45], v[108:109], s[74:75], v[12:13] op_sel_hi:[1,1,0]
    v_pk_fma_f32 v[46:47], v[110:111], s[74:75], v[12:13] op_sel_hi:[1,1,0]
    s_mov_b64 exec, 1
    ds_add_u32 v242, v243 offset:12
    s_mov_b64 exec, -1
    s_mov_b32 s52, s32
    s_mov_b32 s53, s33
    s_mov_b32 s54, 401408
    s_mov_b32 s55, 0x00020000
    s_mul_i32 s62, s7, 100352
    s_lshl_b32 s63, s78, 7
    s_add_u32 s62, s62, s63
    s_mov_b32 s63, s56
    s_waitcnt lgkmcnt(0)
    s_mov_b32 m0, s63
    s_addk_i32 s63, 1024
    buffer_load_dwordx4 v247, s[52:55], s62 offen lds
    s_addk_i32 s62, 7168
    v_exp_f32 v16, v16
    v_exp_f32 v17, v17
    v_exp_f32 v18, v18
    v_exp_f32 v19, v19
    s_mov_b32 m0, s63
    s_addk_i32 s63, 1024
    buffer_load_dwordx4 v247, s[52:55], s62 offen lds
    s_addk_i32 s62, 7168
    v_exp_f32 v20, v20
    v_exp_f32 v21, v21
    v_exp_f32 v22, v22
    v_mov_b32 v23, 0
    v_exp_f32 v24, v24
    s_mov_b32 m0, s63
    s_addk_i32 s63, 1024
    buffer_load_dwordx4 v247, s[52:55], s62 offen lds
    s_addk_i32 s62, 7168
    v_exp_f32 v25, v25
    v_exp_f32 v26, v26
    v_exp_f32 v27, v27
    v_exp_f32 v28, v28
    s_mov_b32 m0, s63
    s_addk_i32 s63, 1024
    buffer_load_dwordx4 v247, s[52:55], s62 offen lds
    s_addk_i32 s62, 7168
    v_exp_f32 v29, v29
    v_exp_f32 v30, v30
    v_mov_b32 v31, 0
    v_exp_f32 v32, v32
    v_exp_f32 v33, v33
    s_mov_b32 m0, s63
    s_addk_i32 s63, 1024
    buffer_load_dwordx4 v247, s[52:55], s62 offen lds
    s_addk_i32 s62, 7168
    v_exp_f32 v34, v34
    v_exp_f32 v35, v35
    v_exp_f32 v36, v36
    v_exp_f32 v37, v37
    s_mov_b32 m0, s63
    s_addk_i32 s63, 1024
    buffer_load_dwordx4 v247, s[52:55], s62 offen lds
    s_addk_i32 s62, 7168
    v_exp_f32 v38, v38
    v_mov_b32 v39, 0
    v_exp_f32 v40, v40
    v_exp_f32 v41, v41
    v_exp_f32 v42, v42
    s_mov_b32 m0, s63
    s_addk_i32 s63, 1024
    buffer_load_dwordx4 v247, s[52:55], s62 offen lds
    s_addk_i32 s62, 7168
    v_exp_f32 v43, v43
    v_exp_f32 v44, v44
    v_exp_f32 v45, v45
    v_exp_f32 v46, v46
    v_mov_b32 v47, 0
    s_lshl_b32 s8, s4, 2
    s_add_u32 s8, s8, s7
    s_lshl_b32 s8, s8, 4
    s_add_u32 s8, s8, s5
    s_lshl_b32 s10, s8, 11
    s_add_u32 s10, s10, 4194304
    s_lshl_b32 s11, s4, 4
    s_lshr_b32 s71, s7, 1
    s_lshl_b32 s71, s71, 3
    s_add_u32 s11, s11, s71
    s_lshl_b32 s11, s11, 2
    s_lshr_b32 s71, s5, 2
    s_add_u32 s11, s11, s71
    s_lshl_b32 s11, s11, 3
    s_and_b32 s71, s7, 1
    s_add_u32 s11, s11, s71
    s_lshl_b32 s11, s11, 2
    s_and_b32 s71, s5, 3
    s_add_u32 s11, s11, s71
    s_lshl_b32 s11, s11, 2
    s_add_u32 s11, s11, 131072
    s_mov_b32 s70, 0
L_sp_54:
    s_load_dwordx16 s[16:31], s[40:41], s59 glc
L_spc_56:
    s_waitcnt lgkmcnt(0)
    s_xor_b64 s[16:17], s[16:17], s[34:35]
    s_xor_b64 s[18:19], s[18:19], s[34:35]
    s_xor_b64 s[20:21], s[20:21], s[34:35]
    s_xor_b64 s[22:23], s[22:23], s[34:35]
    s_xor_b64 s[24:25], s[24:25], s[34:35]
    s_xor_b64 s[26:27], s[26:27], s[34:35]
    s_xor_b64 s[28:29], s[28:29], s[34:35]
    s_xor_b64 s[30:31], s[30:31], s[34:35]
    s_or_b64 s[16:17], s[16:17], s[18:19]
    s_or_b64 s[16:17], s[16:17], s[20:21]
    s_or_b64 s[16:17], s[16:17], s[22:23]
    s_or_b64 s[16:17], s[16:17], s[24:25]
    s_or_b64 s[16:17], s[16:17], s[26:27]
    s_or_b64 s[16:17], s[16:17], s[28:29]
    s_or_b64 s[16:17], s[16:17], s[30:31]
    s_cbranch_scc0 L_spd_55
    s_sleep 2
    s_add_u32 s70, s70, 1
    s_cmp_lt_u32 s70, 100000
    s_cbranch_scc1 L_sp_54
L_spd_55:
    buffer_load_dwordx4 v[112:115], v241, s[48:51], s13 offen offset:0 sc1
    buffer_load_dwordx4 v[116:119], v241, s[48:51], s13 offen offset:1024 sc1
    buffer_load_dwordx4 v[120:123], v241, s[48:51], s13 offen offset:2048 sc1
    buffer_load_dwordx4 v[124:127], v241, s[48:51], s13 offen offset:3072 sc1
    s_mov_b32 s70, 0
L_wk2:
    s_waitcnt vmcnt(0)
    v_xor_b32 v115, s39, v115
    v_xor_b32 v119, s39, v119
    v_xor_b32 v123, s39, v123
    v_xor_b32 v127, s39, v127
    v_or3_b32 v10, v115, v119, v123
    v_or_b32 v10, v10, v127
    v_cmp_lt_u32 vcc, s76, v10
    s_nop 0
    s_cbranch_vccnz L_rk2
L_kk2:
    v_permlane32_swap_b32 v112, v114
    v_permlane32_swap_b32 v113, v115
    v_permlane32_swap_b32 v116, v118
    v_permlane32_swap_b32 v117, v119
    v_permlane32_swap_b32 v120, v122
    v_permlane32_swap_b32 v121, v123
    v_permlane32_swap_b32 v124, v126
    v_permlane32_swap_b32 v125, v127
    v_smfmac_f32_32x32x32_bf16 v[64:79], v[112:115], v[16:23], v240
    v_smfmac_f32_32x32x32_bf16 v[64:79], v[116:119], v[24:31], v240
    v_smfmac_f32_32x32x32_bf16 v[128:143], v[120:123], v[32:39], v240
    v_smfmac_f32_32x32x32_bf16 v[128:143], v[124:127], v[40:47], v240
    s_nop 9
    v_rcp_f32 v10, v79
    s_nop 0
    v_rcp_f32 v12, v143
    v_mov_b32 v13, 0x358637bd
    v_fma_f32 v13, v71, v10, v13
    v_fma_f32 v13, v135, v12, v13
    v_rcp_f32 v13, v13
    s_nop 0
    v_mul_f32 v13, v13, v14
    v_mul_f32 v10, v10, v13
    v_mul_f32 v12, v12, v13
    v_pk_mul_f32 v[64:65], v[64:65], v[10:11] op_sel_hi:[1,0]
    v_pk_mul_f32 v[66:67], v[66:67], v[10:11] op_sel_hi:[1,0]
    v_pk_mul_f32 v[68:69], v[68:69], v[10:11] op_sel_hi:[1,0]
    v_pk_mul_f32 v[70:71], v[70:71], v[10:11] op_sel_hi:[1,0]
    v_pk_mul_f32 v[72:73], v[72:73], v[10:11] op_sel_hi:[1,0]
    v_pk_mul_f32 v[74:75], v[74:75], v[10:11] op_sel_hi:[1,0]
    v_pk_mul_f32 v[76:77], v[76:77], v[10:11] op_sel_hi:[1,0]
    v_pk_mul_f32 v[78:79], v[78:79], v[10:11] op_sel_hi:[1,0]
    v_pk_fma_f32 v[64:65], v[128:129], v[12:13], v[64:65] op_sel_hi:[1,0,1]
    v_pk_fma_f32 v[66:67], v[130:131], v[12:13], v[66:67] op_sel_hi:[1,0,1]
    v_pk_fma_f32 v[68:69], v[132:133], v[12:13], v[68:69] op_sel_hi:[1,0,1]
    v_pk_fma_f32 v[70:71], v[134:135], v[12:13], v[70:71] op_sel_hi:[1,0,1]
    v_pk_fma_f32 v[72:73], v[136:137], v[12:13], v[72:73] op_sel_hi:[1,0,1]
    v_pk_fma_f32 v[74:75], v[138:139], v[12:13], v[74:75] op_sel_hi:[1,0,1]
    v_pk_fma_f32 v[76:77], v[140:141], v[12:13], v[76:77] op_sel_hi:[1,0,1]
    v_pk_fma_f32 v[78:79], v[142:143], v[12:13], v[78:79] op_sel_hi:[1,0,1]
    v_cvt_pk_bf16_f32 v88, v64, v65
    v_cvt_pk_bf16_f32 v89, v66, v67
    v_cvt_pk_bf16_f32 v90, v68, v69
    v_cvt_pk_bf16_f32 v91, v70, s39
    buffer_store_dwordx4 v[88:91], v241, s[48:51], s10 offen sc1
    v_cvt_pk_bf16_f32 v92, v72, v73
    v_cvt_pk_bf16_f32 v93, v74, v75
    v_cvt_pk_bf16_f32 v94, v76, v77
    v_cvt_pk_bf16_f32 v95, v78, s39
    buffer_store_dwordx4 v[92:95], v241, s[48:51], s10 offen offset:1024 sc1
    v_lshlrev_b32 v10, 5, v241
    s_mov_b64 exec, 0x7f
    buffer_store_dword v248, v10, s[48:51], s11 offen sc1
    s_mov_b64 exec, -1
    s_and_b32 s8, s5, 7
    s_cmp_eq_u32 s8, 7
    s_cbranch_scc1 L_done
    s_mov_b32 m0, s63
    s_addk_i32 s63, 1024
    buffer_load_dwordx4 v247, s[52:55], s62 offen lds
    s_addk_i32 s62, 7168
    s_mov_b32 m0, s63
    s_addk_i32 s63, 1024
    buffer_load_dwordx4 v247, s[52:55], s62 offen lds
    s_addk_i32 s62, 7168
    s_mov_b32 m0, s63
    s_addk_i32 s63, 1024
    buffer_load_dwordx4 v247, s[52:55], s62 offen lds
    s_addk_i32 s62, 7168
    s_mov_b32 m0, s63
    s_addk_i32 s63, 1024
    buffer_load_dwordx4 v247, s[52:55], s62 offen lds
    s_addk_i32 s62, 7168
    s_mov_b32 m0, s63
    s_addk_i32 s63, 1024
    buffer_load_dwordx4 v247, s[52:55], s62 offen lds
    s_addk_i32 s62, 7168
    s_waitcnt vmcnt(4)
    s_mov_b32 m0, s63
    s_addk_i32 s63, 1024
    buffer_load_dwordx4 v247, s[52:55], s62 offen lds
    s_addk_i32 s62, 7168
    s_waitcnt vmcnt(4)
    s_mov_b32 m0, s63
    s_addk_i32 s63, 1024
    buffer_load_dwordx4 v247, s[52:55], s62 offen lds
    s_addk_i32 s62, 7168
    s_waitcnt vmcnt(4)
    s_lshl_b32 s79, s4, 2
    s_lshl_b32 s9, s77, 1
    s_add_u32 s79, s79, s9
    s_lshl_b32 s79, s79, 4
    s_lshl_b32 s9, s7, 2
    s_add_u32 s79, s79, s9
    s_lshl_b32 s8, s4, 4
    s_add_u32 s8, s8, s5
    s_lshl_b32 s8, s8, 2
    s_add_u32 s8, s8, s7
    s_lshl_b32 s8, s8, 7
    s_add_u32 s78, s8, 655360
    s_add_u32 s8, s8, 131072
    s_lshl_b32 s12, s79, 11
    s_add_u32 s12, s12, 4194304
    s_add_u32 s13, s12, 32768
    s_add_u32 s14, s12, 4096
    s_add_u32 s15, s13, 4096
    s_mov_b32 s70, 0
L_sp_57:
    s_load_dwordx8 s[16:23], s[40:41], s8 glc
L_spc_59:
    s_waitcnt lgkmcnt(0)
    s_xor_b64 s[16:17], s[16:17], s[34:35]
    s_xor_b64 s[18:19], s[18:19], s[34:35]
    s_xor_b64 s[20:21], s[20:21], s[34:35]
    s_xor_b64 s[22:23], s[22:23], s[34:35]
    s_or_b64 s[16:17], s[16:17], s[18:19]
    s_or_b64 s[16:17], s[16:17], s[20:21]
    s_or_b64 s[16:17], s[16:17], s[22:23]
    s_cbranch_scc0 L_spd_58
    s_sleep 2
    s_add_u32 s70, s70, 1
    s_cmp_lt_u32 s70, 100000
    s_cbranch_scc1 L_sp_57
L_spd_58:
    v_mov_b32 v10, v241
    v_mov_b32 v11, v241
    s_setprio 0
    buffer_load_dwordx4 v[112:115], v10, s[48:51], s12 offen sc1
    v_add_u32 v10, 1024, v10
    buffer_load_dwordx4 v[116:119], v11, s[48:51], s13 offen sc1
    v_add_u32 v11, 1024, v11
    buffer_load_dwordx4 v[120:123], v10, s[48:51], s12 offen sc1
    v_add_u32 v10, 1024, v10
    buffer_load_dwordx4 v[124:127], v11, s[48:51], s13 offen sc1
    v_add_u32 v11, 1024, v11
    buffer_load_dwordx4 v[128:131], v10, s[48:51], s12 offen sc1
    v_add_u32 v10, 1024, v10
    buffer_load_dwordx4 v[132:135], v11, s[48:51], s13 offen sc1
    v_add_u32 v11, 1024, v11
    buffer_load_dwordx4 v[136:139], v10, s[48:51], s12 offen sc1
    v_add_u32 v10, 1024, v10
    buffer_load_dwordx4 v[140:143], v11, s[48:51], s13 offen sc1
    v_add_u32 v11, 1024, v11
    buffer_load_dwordx4 v[144:147], v10, s[48:51], s12 offen sc1
    v_add_u32 v10, 1024, v10
    buffer_load_dwordx4 v[148:151], v11, s[48:51], s13 offen sc1
    v_add_u32 v11, 1024, v11
    buffer_load_dwordx4 v[152:155], v10, s[48:51], s12 offen sc1
    v_add_u32 v10, 1024, v10
    buffer_load_dwordx4 v[156:159], v11, s[48:51], s13 offen sc1
    v_add_u32 v11, 1024, v11
    buffer_load_dwordx4 v[160:163], v10, s[48:51], s12 offen sc1
    v_add_u32 v10, 1024, v10
    buffer_load_dwordx4 v[164:167], v11, s[48:51], s13 offen sc1
    v_add_u32 v11, 1024, v11
    buffer_load_dwordx4 v[168:171], v10, s[48:51], s12 offen sc1
    buffer_load_dwordx4 v[172:175], v11, s[48:51], s13 offen sc1
    s_setprio 2
    s_mov_b32 s70, 0
L_wa0:
    s_waitcnt vmcnt(14)
    v_xor_b32 v115, s39, v115
    v_xor_b32 v119, s39, v119
    v_or_b32 v10, v115, v119
    v_cmp_lt_u32 vcc, s76, v10
    s_nop 0
    s_cbranch_vccnz L_ra0
L_ka0:
L_wa1:
    s_waitcnt vmcnt(12)
    v_xor_b32 v123, s39, v123
    v_xor_b32 v127, s39, v127
    v_or_b32 v10, v123, v127
    v_cmp_lt_u32 vcc, s76, v10
    s_nop 0
    s_cbranch_vccnz L_ra1
L_ka1:
L_wa2:
    s_waitcnt vmcnt(10)
    v_xor_b32 v131, s39, v131
    v_xor_b32 v135, s39, v135
    v_or_b32 v10, v131, v135
    v_cmp_lt_u32 vcc, s76, v10
    s_nop 0
    s_cbranch_vccnz L_ra2
L_ka2:
L_wa3:
    s_waitcnt vmcnt(8)
    v_xor_b32 v139, s39, v139
    v_xor_b32 v143, s39, v143
    v_or_b32 v10, v139, v143
    v_cmp_lt_u32 vcc, s76, v10
    s_nop 0
    s_cbranch_vccnz L_ra3
L_ka3:
L_wa4:
    s_waitcnt vmcnt(6)
    v_xor_b32 v147, s39, v147
    v_xor_b32 v151, s39, v151
    v_or_b32 v10, v147, v151
    v_cmp_lt_u32 vcc, s76, v10
    s_nop 0
    s_cbranch_vccnz L_ra4
L_ka4:
L_wa5:
    s_waitcnt vmcnt(4)
    v_xor_b32 v155, s39, v155
    v_xor_b32 v159, s39, v159
    v_or_b32 v10, v155, v159
    v_cmp_lt_u32 vcc, s76, v10
    s_nop 0
    s_cbranch_vccnz L_ra5
L_ka5:
L_wa6:
    s_waitcnt vmcnt(2)
    v_xor_b32 v163, s39, v163
    v_xor_b32 v167, s39, v167
    v_or_b32 v10, v163, v167
    v_cmp_lt_u32 vcc, s76, v10
    s_nop 0
    s_cbranch_vccnz L_ra6
L_ka6:
L_wa7:
    s_waitcnt vmcnt(0)
    v_xor_b32 v171, s39, v171
    v_xor_b32 v175, s39, v175
    v_or_b32 v10, v171, v175
    v_cmp_lt_u32 vcc, s76, v10
    s_nop 0
    s_cbranch_vccnz L_ra7
L_ka7:
    s_mov_b32 s70, 0
L_lw_60:
    ds_read_b32 v244, v242 offset:32
    s_waitcnt lgkmcnt(0)
    v_readfirstlane_b32 s71, v244
    s_nop 0
    s_cmp_ge_u32 s71, 4
    s_cbranch_scc1 L_lwd_61
    s_sleep 1
    s_add_u32 s70, s70, 1
    s_cmp_lt_u32 s70, 800000
    s_cbranch_scc1 L_lw_60
L_lwd_61:
    s_setprio 1
    s_waitcnt vmcnt(0)
    v_mfma_f32_32x32x16_bf16 v[48:63], v[176:179], v[112:115], 0
    v_mfma_f32_32x32x16_bf16 v[64:79], v[180:183], v[112:115], 0
    v_mfma_f32_32x32x16_bf16 v[80:95], v[176:179], v[116:119], 0
    v_mfma_f32_32x32x16_bf16 v[96:111], v[180:183], v[116:119], 0
    ds_read_b64_tr_b16 v[176:177], v2 offset:0
    ds_read_b64_tr_b16 v[178:179], v6 offset:0
    ds_read_b64_tr_b16 v[180:181], v2 offset:64
    ds_read_b64_tr_b16 v[182:183], v6 offset:64
    v_mfma_f32_32x32x16_bf16 v[48:63], v[184:187], v[120:123], v[48:63]
    v_mfma_f32_32x32x16_bf16 v[64:79], v[188:191], v[120:123], v[64:79]
    v_mfma_f32_32x32x16_bf16 v[80:95], v[184:187], v[124:127], v[80:95]
    v_mfma_f32_32x32x16_bf16 v[96:111], v[188:191], v[124:127], v[96:111]
    ds_read_b64_tr_b16 v[184:185], v2 offset:1792
    ds_read_b64_tr_b16 v[186:187], v6 offset:1792
    ds_read_b64_tr_b16 v[188:189], v2 offset:1856
    ds_read_b64_tr_b16 v[190:191], v6 offset:1856
    s_waitcnt lgkmcnt(4)
    v_mfma_f32_32x32x16_bf16 v[48:63], v[192:195], v[128:131], v[48:63]
    v_mfma_f32_32x32x16_bf16 v[64:79], v[196:199], v[128:131], v[64:79]
    v_mfma_f32_32x32x16_bf16 v[80:95], v[192:195], v[132:135], v[80:95]
    v_mfma_f32_32x32x16_bf16 v[96:111], v[196:199], v[132:135], v[96:111]
    ds_read_b64_tr_b16 v[192:193], v2 offset:3584
    ds_read_b64_tr_b16 v[194:195], v6 offset:3584
    ds_read_b64_tr_b16 v[196:197], v2 offset:3648
    ds_read_b64_tr_b16 v[198:199], v6 offset:3648
    v_mfma_f32_32x32x16_bf16 v[48:63], v[200:203], v[136:139], v[48:63]
    v_mfma_f32_32x32x16_bf16 v[64:79], v[204:207], v[136:139], v[64:79]
    v_mfma_f32_32x32x16_bf16 v[80:95], v[200:203], v[140:143], v[80:95]
    v_mfma_f32_32x32x16_bf16 v[96:111], v[204:207], v[140:143], v[96:111]
    ds_read_b64_tr_b16 v[200:201], v2 offset:5376
    ds_read_b64_tr_b16 v[202:203], v6 offset:5376
    ds_read_b64_tr_b16 v[204:205], v2 offset:5440
    ds_read_b64_tr_b16 v[206:207], v6 offset:5440
    s_waitcnt lgkmcnt(4)
    v_mfma_f32_32x32x16_bf16 v[48:63], v[208:211], v[144:147], v[48:63]
    v_mfma_f32_32x32x16_bf16 v[64:79], v[212:215], v[144:147], v[64:79]
    v_mfma_f32_32x32x16_bf16 v[80:95], v[208:211], v[148:151], v[80:95]
    v_mfma_f32_32x32x16_bf16 v[96:111], v[212:215], v[148:151], v[96:111]
    ds_read_b64_tr_b16 v[208:209], v2 offset:7168
    ds_read_b64_tr_b16 v[210:211], v6 offset:7168
    ds_read_b64_tr_b16 v[212:213], v2 offset:7232
    ds_read_b64_tr_b16 v[214:215], v6 offset:7232
    s_load_dwordx8 s[16:23], s[40:41], s78 glc
    v_mfma_f32_32x32x16_bf16 v[48:63], v[216:219], v[152:155], v[48:63]
    v_mfma_f32_32x32x16_bf16 v[64:79], v[220:223], v[152:155], v[64:79]
    v_mfma_f32_32x32x16_bf16 v[80:95], v[216:219], v[156:159], v[80:95]
    v_mfma_f32_32x32x16_bf16 v[96:111], v[220:223], v[156:159], v[96:111]
    ds_read_b64_tr_b16 v[216:217], v2 offset:8960
    ds_read_b64_tr_b16 v[218:219], v6 offset:8960
    ds_read_b64_tr_b16 v[220:221], v2 offset:9024
    ds_read_b64_tr_b16 v[222:223], v6 offset:9024
    s_waitcnt lgkmcnt(4)
    v_mfma_f32_32x32x16_bf16 v[48:63], v[224:227], v[160:163], v[48:63]
    v_mfma_f32_32x32x16_bf16 v[64:79], v[228:231], v[160:163], v[64:79]
    v_mfma_f32_32x32x16_bf16 v[80:95], v[224:227], v[164:167], v[80:95]
    v_mfma_f32_32x32x16_bf16 v[96:111], v[228:231], v[164:167], v[96:111]
    ds_read_b64_tr_b16 v[224:225], v2 offset:10752
    ds_read_b64_tr_b16 v[226:227], v6 offset:10752
    ds_read_b64_tr_b16 v[228:229], v2 offset:10816
    ds_read_b64_tr_b16 v[230:231], v6 offset:10816
    v_mfma_f32_32x32x16_bf16 v[48:63], v[232:235], v[168:171], v[48:63]
    v_mfma_f32_32x32x16_bf16 v[64:79], v[236:239], v[168:171], v[64:79]
    v_mfma_f32_32x32x16_bf16 v[80:95], v[232:235], v[172:175], v[80:95]
    v_mfma_f32_32x32x16_bf16 v[96:111], v[236:239], v[172:175], v[96:111]
    ds_read_b64_tr_b16 v[232:233], v2 offset:12544
    ds_read_b64_tr_b16 v[234:235], v6 offset:12544
    ds_read_b64_tr_b16 v[236:237], v2 offset:12608
    ds_read_b64_tr_b16 v[238:239], v6 offset:12608
    s_waitcnt lgkmcnt(4)
    s_lshl_b32 s12, s79, 11
    s_add_u32 s12, s12, 6291456
    s_add_u32 s13, s12, 32768
    s_add_u32 s14, s12, 4096
    s_add_u32 s15, s13, 4096
    s_mov_b32 s70, 0
    s_branch L_spc_64
L_sp_62:
    s_load_dwordx8 s[16:23], s[40:41], s78 glc
L_spc_64:
    s_waitcnt lgkmcnt(0)
    s_xor_b64 s[16:17], s[16:17], s[34:35]
    s_xor_b64 s[18:19], s[18:19], s[34:35]
    s_xor_b64 s[20:21], s[20:21], s[34:35]
    s_xor_b64 s[22:23], s[22:23], s[34:35]
    s_or_b64 s[16:17], s[16:17], s[18:19]
    s_or_b64 s[16:17], s[16:17], s[20:21]
    s_or_b64 s[16:17], s[16:17], s[22:23]
    s_cbranch_scc0 L_spd_63
    s_sleep 0
    s_add_u32 s70, s70, 1
    s_cmp_lt_u32 s70, 100000
    s_cbranch_scc1 L_sp_62
L_spd_63:
    buffer_load_dwordx4 v[112:115], v241, s[48:51], s12 offen offset:0 sc1
    buffer_load_dwordx4 v[120:123], v241, s[48:51], s12 offen offset:1024 sc1
    buffer_load_dwordx4 v[128:131], v241, s[48:51], s12 offen offset:2048 sc1
    buffer_load_dwordx4 v[136:139], v241, s[48:51], s12 offen offset:3072 sc1
    buffer_load_dwordx4 v[144:147], v241, s[48:51], s14 offen offset:0 sc1
    buffer_load_dwordx4 v[152:155], v241, s[48:51], s14 offen offset:1024 sc1
    buffer_load_dwordx4 v[160:163], v241, s[48:51], s14 offen offset:2048 sc1
    buffer_load_dwordx4 v[168:171], v241, s[48:51], s14 offen offset:3072 sc1
    buffer_load_dwordx4 v[116:119], v241, s[48:51], s13 offen offset:0 sc1
    buffer_load_dwordx4 v[124:127], v241, s[48:51], s13 offen offset:1024 sc1
    buffer_load_dwordx4 v[132:135], v241, s[48:51], s13 offen offset:2048 sc1
    buffer_load_dwordx4 v[140:143], v241, s[48:51], s13 offen offset:3072 sc1
    buffer_load_dwordx4 v[148:151], v241, s[48:51], s15 offen offset:0 sc1
    buffer_load_dwordx4 v[156:159], v241, s[48:51], s15 offen offset:1024 sc1
    buffer_load_dwordx4 v[164:167], v241, s[48:51], s15 offen offset:2048 sc1
    buffer_load_dwordx4 v[172:175], v241, s[48:51], s15 offen offset:3072 sc1
    s_mov_b32 s70, 0
    s_waitcnt lgkmcnt(0)
L_wb0:
    s_waitcnt vmcnt(14)
    v_xor_b32 v115, s39, v115
    v_xor_b32 v123, s39, v123
    v_or_b32 v10, v115, v123
    v_cmp_lt_u32 vcc, s76, v10
    s_nop 0
    s_cbranch_vccnz L_rb0
L_kb0:
    v_mfma_f32_32x32x16_bf16 v[48:63], v[176:179], v[112:115], v[48:63]
    v_mfma_f32_32x32x16_bf16 v[64:79], v[180:183], v[112:115], v[64:79]
    v_mfma_f32_32x32x16_bf16 v[48:63], v[184:187], v[120:123], v[48:63]
    v_mfma_f32_32x32x16_bf16 v[64:79], v[188:191], v[120:123], v[64:79]
L_wb2:
    s_waitcnt vmcnt(12)
    v_xor_b32 v131, s39, v131
    v_xor_b32 v139, s39, v139
    v_or_b32 v10, v131, v139
    v_cmp_lt_u32 vcc, s76, v10
    s_nop 0
    s_cbranch_vccnz L_rb2
L_kb2:
    v_mfma_f32_32x32x16_bf16 v[48:63], v[192:195], v[128:131], v[48:63]
    v_mfma_f32_32x32x16_bf16 v[64:79], v[196:199], v[128:131], v[64:79]
    v_mfma_f32_32x32x16_bf16 v[48:63], v[200:203], v[136:139], v[48:63]
    v_mfma_f32_32x32x16_bf16 v[64:79], v[204:207], v[136:139], v[64:79]
L_wb4:
    s_waitcnt vmcnt(10)
    v_xor_b32 v147, s39, v147
    v_xor_b32 v155, s39, v155
    v_or_b32 v10, v147, v155
    v_cmp_lt_u32 vcc, s76, v10
    s_nop 0
    s_cbranch_vccnz L_rb4
L_kb4:
    v_mfma_f32_32x32x16_bf16 v[48:63], v[208:211], v[144:147], v[48:63]
    v_mfma_f32_32x32x16_bf16 v[64:79], v[212:215], v[144:147], v[64:79]
    v_mfma_f32_32x32x16_bf16 v[48:63], v[216:219], v[152:155], v[48:63]
    v_mfma_f32_32x32x16_bf16 v[64:79], v[220:223], v[152:155], v[64:79]
L_wb6:
    s_waitcnt vmcnt(8)
    v_xor_b32 v163, s39, v163
    v_xor_b32 v171, s39, v171
    v_or_b32 v10, v163, v171
    v_cmp_lt_u32 vcc, s76, v10
    s_nop 0
    s_cbranch_vccnz L_rb6
L_kb6:
    v_mfma_f32_32x32x16_bf16 v[48:63], v[224:227], v[160:163], v[48:63]
    v_mfma_f32_32x32x16_bf16 v[64:79], v[228:231], v[160:163], v[64:79]
    v_mfma_f32_32x32x16_bf16 v[48:63], v[232:235], v[168:171], v[48:63]
    v_mfma_f32_32x32x16_bf16 v[64:79], v[236:239], v[168:171], v[64:79]
L_wb8:
    s_waitcnt vmcnt(6)
    v_xor_b32 v119, s39, v119
    v_xor_b32 v127, s39, v127
    v_or_b32 v10, v119, v127
    v_cmp_lt_u32 vcc, s76, v10
    s_nop 0
    s_cbranch_vccnz L_rb8
L_kb8:
    v_mfma_f32_32x32x16_bf16 v[80:95], v[176:179], v[116:119], v[80:95]
    v_mfma_f32_32x32x16_bf16 v[96:111], v[180:183], v[116:119], v[96:111]
    v_mfma_f32_32x32x16_bf16 v[80:95], v[184:187], v[124:127], v[80:95]
    v_mfma_f32_32x32x16_bf16 v[96:111], v[188:191], v[124:127], v[96:111]
L_wb10:
    s_waitcnt vmcnt(4)
    v_xor_b32 v135, s39, v135
    v_xor_b32 v143, s39, v143
    v_or_b32 v10, v135, v143
    v_cmp_lt_u32 vcc, s76, v10
    s_nop 0
    s_cbranch_vccnz L_rb10
L_kb10:
    v_mfma_f32_32x32x16_bf16 v[80:95], v[192:195], v[132:135], v[80:95]
    ds_write_b128 v8, v[48:51] offset:0
    ds_write_b128 v8, v[52:55] offset:32
    v_mfma_f32_32x32x16_bf16 v[96:111], v[196:199], v[132:135], v[96:111]
    ds_write_b128 v8, v[56:59] offset:64
    ds_write_b128 v8, v[60:63] offset:96
    v_mfma_f32_32x32x16_bf16 v[80:95], v[200:203], v[140:143], v[80:95]
    ds_write_b128 v8, v[64:67] offset:128
    ds_write_b128 v8, v[68:71] offset:160
    v_mfma_f32_32x32x16_bf16 v[96:111], v[204:207], v[140:143], v[96:111]
    ds_write_b128 v8, v[72:75] offset:192
    ds_write_b128 v8, v[76:79] offset:224
L_wb12:
    s_waitcnt vmcnt(2)
    v_xor_b32 v151, s39, v151
    v_xor_b32 v159, s39, v159
    v_or_b32 v10, v151, v159
    v_cmp_lt_u32 vcc, s76, v10
    s_nop 0
    s_cbranch_vccnz L_rb12
L_kb12:
L_wb14:
    s_waitcnt vmcnt(0)
    v_xor_b32 v167, s39, v167
    v_xor_b32 v175, s39, v175
    v_or_b32 v10, v167, v175
    v_cmp_lt_u32 vcc, s76, v10
    s_nop 0
    s_cbranch_vccnz L_rb14
L_kb14:
    s_mov_b64 exec, 1
    ds_add_u32 v242, v243 offset:84
    s_mov_b64 exec, -1
    v_mfma_f32_32x32x16_bf16 v[80:95], v[208:211], v[148:151], v[80:95]
    v_mfma_f32_32x32x16_bf16 v[80:95], v[216:219], v[156:159], v[80:95]
    v_mfma_f32_32x32x16_bf16 v[80:95], v[224:227], v[164:167], v[80:95]
    v_mfma_f32_32x32x16_bf16 v[80:95], v[232:235], v[172:175], v[80:95]
    v_mfma_f32_32x32x16_bf16 v[96:111], v[212:215], v[148:151], v[96:111]
    v_mfma_f32_32x32x16_bf16 v[96:111], v[220:223], v[156:159], v[96:111]
    v_mfma_f32_32x32x16_bf16 v[96:111], v[228:231], v[164:167], v[96:111]
    v_mfma_f32_32x32x16_bf16 v[96:111], v[236:239], v[172:175], v[96:111]
    s_nop 7
    ds_write_b128 v8, v[80:83] offset:8704
    ds_write_b128 v8, v[84:87] offset:8736
    ds_write_b128 v8, v[88:91] offset:8768
    ds_write_b128 v8, v[92:95] offset:8800
    ds_write_b128 v8, v[96:99] offset:8832
    ds_write_b128 v8, v[100:103] offset:8864
    ds_write_b128 v8, v[104:107] offset:8896
    ds_write_b128 v8, v[108:111] offset:8928
    s_mov_b64 exec, 1
    ds_add_u32 v242, v243 offset:88
    s_mov_b64 exec, -1
L_final:
    s_and_b32 s8, s5, 7
    s_cmp_eq_u32 s8, 7
    s_cbranch_scc1 L_done
    s_mov_b32 s52, s36
    s_mov_b32 s53, s37
    s_mov_b32 s54, 1835008
    s_mov_b32 s55, 0x00020000
    v_lshrrev_b32 v10, 3, v0
    v_and_b32 v11, 7, v0
    v_mul_u32_u24 v12, 272, v10
    v_lshl_add_u32 v12, v11, 5, v12
    v_add_u32 v14, 111616, v12
    v_mul_u32_u24 v13, 896, v10
    v_lshl_add_u32 v13, v11, 4, v13
    s_lshr_b32 s8, s5, 3
    s_lshl_b32 s9, s4, 1
    s_add_u32 s8, s8, s9
    s_mul_i32 s8, s8, 57344
    s_and_b32 s9, s5, 7
    s_lshl_b32 s9, s9, 7
    s_add_u32 s8, s8, s9
    s_and_b32 s9, s3, 4
    v_add_u32 v242, s9, v242
    s_cmp_ge_u32 s3, 4
    s_cbranch_scc1 L_fw
    s_mov_b32 s70, 0
L_lw_65:
    ds_read_b32 v244, v242 offset:84
    s_waitcnt lgkmcnt(0)
    v_readfirstlane_b32 s71, v244
    s_nop 0
    s_cmp_ge_u32 s71, 1
    s_cbranch_scc1 L_lwd_66
    s_sleep 2
    s_add_u32 s70, s70, 1
    s_cmp_lt_u32 s70, 800000
    s_cbranch_scc1 L_lw_65
L_lwd_66:
L_fw:
    s_mov_b32 s70, 0
L_lw_67:
    ds_read_b32 v244, v242 offset:84
    s_waitcnt lgkmcnt(0)
    v_readfirstlane_b32 s71, v244
    s_nop 0
    s_cmp_ge_u32 s71, 4
    s_cbranch_scc1 L_lwd_68
    s_add_u32 s70, s70, 1
    s_cmp_lt_u32 s70, 800000
    s_cbranch_scc1 L_lw_67
L_lwd_68:
    ds_read_b128 v[16:19], v12 offset:31744
    ds_read_b128 v[20:23], v12 offset:31760
    ds_read_b128 v[24:27], v12 offset:14336
    ds_read_b128 v[28:31], v12 offset:14352
    ds_read_b128 v[32:35], v14 offset:0
    ds_read_b128 v[36:39], v14 offset:16
    ds_read_b128 v[40:43], v14 offset:17408
    ds_read_b128 v[44:47], v14 offset:17424
    s_waitcnt lgkmcnt(4)
    v_pk_add_f32 v[16:17], v[16:17], v[24:25]
    v_pk_add_f32 v[18:19], v[18:19], v[26:27]
    v_pk_add_f32 v[20:21], v[20:21], v[28:29]
    v_pk_add_f32 v[22:23], v[22:23], v[30:31]
    s_waitcnt lgkmcnt(2)
    v_pk_add_f32 v[16:17], v[16:17], v[32:33]
    v_pk_add_f32 v[18:19], v[18:19], v[34:35]
    v_pk_add_f32 v[20:21], v[20:21], v[36:37]
    v_pk_add_f32 v[22:23], v[22:23], v[38:39]
    s_waitcnt lgkmcnt(0)
    v_pk_add_f32 v[16:17], v[16:17], v[40:41]
    v_pk_add_f32 v[18:19], v[18:19], v[42:43]
    v_pk_add_f32 v[20:21], v[20:21], v[44:45]
    v_pk_add_f32 v[22:23], v[22:23], v[46:47]
    v_cvt_pk_bf16_f32 v24, v16, v17
    v_cvt_pk_bf16_f32 v25, v18, v19
    v_cvt_pk_bf16_f32 v26, v20, v21
    v_cvt_pk_bf16_f32 v27, v22, v23
    buffer_store_dwordx4 v[24:27], v13, s[52:55], s8 offen sc1
    s_xor_b32 s8, s3, 4
    s_or_b32 s8, s2, s8
    s_cmp_lg_u32 s8, 0
    s_cbranch_scc1 L_done
    s_mov_b32 s11, 389120
    s_mov_b64 exec, 1
    buffer_store_dwordx2 v[248:249], v246, s[48:51], s11 offen sc1
    s_mov_b64 exec, -1
L_done:
L_end:
    s_endpgm
L_rkv:
    s_add_u32 s70, s70, 1
    s_cmp_ge_u32 s70, 4000
    s_cbranch_scc1 L_kkv
    s_sleep 4
    buffer_load_dwordx4 v[96:99], v241, s[48:51], s12 offen offset:0 sc1
    buffer_load_dwordx4 v[100:103], v241, s[48:51], s12 offen offset:1024 sc1
    buffer_load_dwordx4 v[104:107], v241, s[48:51], s12 offen offset:2048 sc1
    buffer_load_dwordx4 v[108:111], v241, s[48:51], s12 offen offset:3072 sc1
    s_branch L_wkv
L_rk2:
    s_add_u32 s70, s70, 1
    s_cmp_ge_u32 s70, 4000
    s_cbranch_scc1 L_kk2
    s_waitcnt vmcnt(0)
    s_sleep 4
    buffer_load_dwordx4 v[112:115], v241, s[48:51], s13 offen offset:0 sc1
    buffer_load_dwordx4 v[116:119], v241, s[48:51], s13 offen offset:1024 sc1
    buffer_load_dwordx4 v[120:123], v241, s[48:51], s13 offen offset:2048 sc1
    buffer_load_dwordx4 v[124:127], v241, s[48:51], s13 offen offset:3072 sc1
    s_branch L_wk2
L_ra0:
    s_add_u32 s70, s70, 1
    s_cmp_ge_u32 s70, 4000
    s_cbranch_scc1 L_ka0
    s_waitcnt vmcnt(0)
    s_sleep 4
    buffer_load_dwordx4 v[112:115], v241, s[48:51], s12 offen offset:0 sc1
    buffer_load_dwordx4 v[116:119], v241, s[48:51], s13 offen offset:0 sc1
    buffer_load_dwordx4 v[120:123], v241, s[48:51], s12 offen offset:1024 sc1
    buffer_load_dwordx4 v[124:127], v241, s[48:51], s13 offen offset:1024 sc1
    buffer_load_dwordx4 v[128:131], v241, s[48:51], s12 offen offset:2048 sc1
    buffer_load_dwordx4 v[132:135], v241, s[48:51], s13 offen offset:2048 sc1
    buffer_load_dwordx4 v[136:139], v241, s[48:51], s12 offen offset:3072 sc1
    buffer_load_dwordx4 v[140:143], v241, s[48:51], s13 offen offset:3072 sc1
    buffer_load_dwordx4 v[144:147], v241, s[48:51], s14 offen offset:0 sc1
    buffer_load_dwordx4 v[148:151], v241, s[48:51], s15 offen offset:0 sc1
    buffer_load_dwordx4 v[152:155], v241, s[48:51], s14 offen offset:1024 sc1
    buffer_load_dwordx4 v[156:159], v241, s[48:51], s15 offen offset:1024 sc1
    buffer_load_dwordx4 v[160:163], v241, s[48:51], s14 offen offset:2048 sc1
    buffer_load_dwordx4 v[164:167], v241, s[48:51], s15 offen offset:2048 sc1
    buffer_load_dwordx4 v[168:171], v241, s[48:51], s14 offen offset:3072 sc1
    buffer_load_dwordx4 v[172:175], v241, s[48:51], s15 offen offset:3072 sc1
    s_waitcnt vmcnt(0)
    s_branch L_wa0
L_ra1:
    s_add_u32 s70, s70, 1
    s_cmp_ge_u32 s70, 4000
    s_cbranch_scc1 L_ka1
    s_waitcnt vmcnt(0)
    s_sleep 4
    buffer_load_dwordx4 v[120:123], v241, s[48:51], s12 offen offset:1024 sc1
    buffer_load_dwordx4 v[124:127], v241, s[48:51], s13 offen offset:1024 sc1
    buffer_load_dwordx4 v[128:131], v241, s[48:51], s12 offen offset:2048 sc1
    buffer_load_dwordx4 v[132:135], v241, s[48:51], s13 offen offset:2048 sc1
    buffer_load_dwordx4 v[136:139], v241, s[48:51], s12 offen offset:3072 sc1
    buffer_load_dwordx4 v[140:143], v241, s[48:51], s13 offen offset:3072 sc1
    buffer_load_dwordx4 v[144:147], v241, s[48:51], s14 offen offset:0 sc1
    buffer_load_dwordx4 v[148:151], v241, s[48:51], s15 offen offset:0 sc1
    buffer_load_dwordx4 v[152:155], v241, s[48:51], s14 offen offset:1024 sc1
    buffer_load_dwordx4 v[156:159], v241, s[48:51], s15 offen offset:1024 sc1
    buffer_load_dwordx4 v[160:163], v241, s[48:51], s14 offen offset:2048 sc1
    buffer_load_dwordx4 v[164:167], v241, s[48:51], s15 offen offset:2048 sc1
    buffer_load_dwordx4 v[168:171], v241, s[48:51], s14 offen offset:3072 sc1
    buffer_load_dwordx4 v[172:175], v241, s[48:51], s15 offen offset:3072 sc1
    s_waitcnt vmcnt(0)
    s_branch L_wa1
L_ra2:
    s_add_u32 s70, s70, 1
    s_cmp_ge_u32 s70, 4000
    s_cbranch_scc1 L_ka2
    s_waitcnt vmcnt(0)
    s_sleep 4
    buffer_load_dwordx4 v[128:131], v241, s[48:51], s12 offen offset:2048 sc1
    buffer_load_dwordx4 v[132:135], v241, s[48:51], s13 offen offset:2048 sc1
    buffer_load_dwordx4 v[136:139], v241, s[48:51], s12 offen offset:3072 sc1
    buffer_load_dwordx4 v[140:143], v241, s[48:51], s13 offen offset:3072 sc1
    buffer_load_dwordx4 v[144:147], v241, s[48:51], s14 offen offset:0 sc1
    buffer_load_dwordx4 v[148:151], v241, s[48:51], s15 offen offset:0 sc1
    buffer_load_dwordx4 v[152:155], v241, s[48:51], s14 offen offset:1024 sc1
    buffer_load_dwordx4 v[156:159], v241, s[48:51], s15 offen offset:1024 sc1
    buffer_load_dwordx4 v[160:163], v241, s[48:51], s14 offen offset:2048 sc1
    buffer_load_dwordx4 v[164:167], v241, s[48:51], s15 offen offset:2048 sc1
    buffer_load_dwordx4 v[168:171], v241, s[48:51], s14 offen offset:3072 sc1
    buffer_load_dwordx4 v[172:175], v241, s[48:51], s15 offen offset:3072 sc1
    s_waitcnt vmcnt(0)
    s_branch L_wa2
L_ra3:
    s_add_u32 s70, s70, 1
    s_cmp_ge_u32 s70, 4000
    s_cbranch_scc1 L_ka3
    s_waitcnt vmcnt(0)
    s_sleep 4
    buffer_load_dwordx4 v[136:139], v241, s[48:51], s12 offen offset:3072 sc1
    buffer_load_dwordx4 v[140:143], v241, s[48:51], s13 offen offset:3072 sc1
    buffer_load_dwordx4 v[144:147], v241, s[48:51], s14 offen offset:0 sc1
    buffer_load_dwordx4 v[148:151], v241, s[48:51], s15 offen offset:0 sc1
    buffer_load_dwordx4 v[152:155], v241, s[48:51], s14 offen offset:1024 sc1
    buffer_load_dwordx4 v[156:159], v241, s[48:51], s15 offen offset:1024 sc1
    buffer_load_dwordx4 v[160:163], v241, s[48:51], s14 offen offset:2048 sc1
    buffer_load_dwordx4 v[164:167], v241, s[48:51], s15 offen offset:2048 sc1
    buffer_load_dwordx4 v[168:171], v241, s[48:51], s14 offen offset:3072 sc1
    buffer_load_dwordx4 v[172:175], v241, s[48:51], s15 offen offset:3072 sc1
    s_waitcnt vmcnt(0)
    s_branch L_wa3
L_ra4:
    s_add_u32 s70, s70, 1
    s_cmp_ge_u32 s70, 4000
    s_cbranch_scc1 L_ka4
    s_waitcnt vmcnt(0)
    s_sleep 4
    buffer_load_dwordx4 v[144:147], v241, s[48:51], s14 offen offset:0 sc1
    buffer_load_dwordx4 v[148:151], v241, s[48:51], s15 offen offset:0 sc1
    buffer_load_dwordx4 v[152:155], v241, s[48:51], s14 offen offset:1024 sc1
    buffer_load_dwordx4 v[156:159], v241, s[48:51], s15 offen offset:1024 sc1
    buffer_load_dwordx4 v[160:163], v241, s[48:51], s14 offen offset:2048 sc1
    buffer_load_dwordx4 v[164:167], v241, s[48:51], s15 offen offset:2048 sc1
    buffer_load_dwordx4 v[168:171], v241, s[48:51], s14 offen offset:3072 sc1
    buffer_load_dwordx4 v[172:175], v241, s[48:51], s15 offen offset:3072 sc1
    s_waitcnt vmcnt(0)
    s_branch L_wa4
L_ra5:
    s_add_u32 s70, s70, 1
    s_cmp_ge_u32 s70, 4000
    s_cbranch_scc1 L_ka5
    s_waitcnt vmcnt(0)
    s_sleep 4
    buffer_load_dwordx4 v[152:155], v241, s[48:51], s14 offen offset:1024 sc1
    buffer_load_dwordx4 v[156:159], v241, s[48:51], s15 offen offset:1024 sc1
    buffer_load_dwordx4 v[160:163], v241, s[48:51], s14 offen offset:2048 sc1
    buffer_load_dwordx4 v[164:167], v241, s[48:51], s15 offen offset:2048 sc1
    buffer_load_dwordx4 v[168:171], v241, s[48:51], s14 offen offset:3072 sc1
    buffer_load_dwordx4 v[172:175], v241, s[48:51], s15 offen offset:3072 sc1
    s_waitcnt vmcnt(0)
    s_branch L_wa5
L_ra6:
    s_add_u32 s70, s70, 1
    s_cmp_ge_u32 s70, 4000
    s_cbranch_scc1 L_ka6
    s_waitcnt vmcnt(0)
    s_sleep 4
    buffer_load_dwordx4 v[160:163], v241, s[48:51], s14 offen offset:2048 sc1
    buffer_load_dwordx4 v[164:167], v241, s[48:51], s15 offen offset:2048 sc1
    buffer_load_dwordx4 v[168:171], v241, s[48:51], s14 offen offset:3072 sc1
    buffer_load_dwordx4 v[172:175], v241, s[48:51], s15 offen offset:3072 sc1
    s_waitcnt vmcnt(0)
    s_branch L_wa6
L_ra7:
    s_add_u32 s70, s70, 1
    s_cmp_ge_u32 s70, 4000
    s_cbranch_scc1 L_ka7
    s_waitcnt vmcnt(0)
    s_sleep 4
    buffer_load_dwordx4 v[168:171], v241, s[48:51], s14 offen offset:3072 sc1
    buffer_load_dwordx4 v[172:175], v241, s[48:51], s15 offen offset:3072 sc1
    s_waitcnt vmcnt(0)
    s_branch L_wa7
L_rb0:
    s_add_u32 s70, s70, 1
    s_cmp_ge_u32 s70, 4000
    s_cbranch_scc1 L_kb0
    s_waitcnt vmcnt(0)
    s_sleep 4
    buffer_load_dwordx4 v[112:115], v241, s[48:51], s12 offen offset:0 sc1
    buffer_load_dwordx4 v[120:123], v241, s[48:51], s12 offen offset:1024 sc1
    buffer_load_dwordx4 v[128:131], v241, s[48:51], s12 offen offset:2048 sc1
    buffer_load_dwordx4 v[136:139], v241, s[48:51], s12 offen offset:3072 sc1
    buffer_load_dwordx4 v[144:147], v241, s[48:51], s14 offen offset:0 sc1
    buffer_load_dwordx4 v[152:155], v241, s[48:51], s14 offen offset:1024 sc1
    buffer_load_dwordx4 v[160:163], v241, s[48:51], s14 offen offset:2048 sc1
    buffer_load_dwordx4 v[168:171], v241, s[48:51], s14 offen offset:3072 sc1
    buffer_load_dwordx4 v[116:119], v241, s[48:51], s13 offen offset:0 sc1
    buffer_load_dwordx4 v[124:127], v241, s[48:51], s13 offen offset:1024 sc1
    buffer_load_dwordx4 v[132:135], v241, s[48:51], s13 offen offset:2048 sc1
    buffer_load_dwordx4 v[140:143], v241, s[48:51], s13 offen offset:3072 sc1
    buffer_load_dwordx4 v[148:151], v241, s[48:51], s15 offen offset:0 sc1
    buffer_load_dwordx4 v[156:159], v241, s[48:51], s15 offen offset:1024 sc1
    buffer_load_dwordx4 v[164:167], v241, s[48:51], s15 offen offset:2048 sc1
    buffer_load_dwordx4 v[172:175], v241, s[48:51], s15 offen offset:3072 sc1
    s_branch L_wb0
L_rb2:
    s_add_u32 s70, s70, 1
    s_cmp_ge_u32 s70, 4000
    s_cbranch_scc1 L_kb2
    s_waitcnt vmcnt(0)
    s_sleep 4
    buffer_load_dwordx4 v[128:131], v241, s[48:51], s12 offen offset:2048 sc1
    buffer_load_dwordx4 v[136:139], v241, s[48:51], s12 offen offset:3072 sc1
    buffer_load_dwordx4 v[144:147], v241, s[48:51], s14 offen offset:0 sc1
    buffer_load_dwordx4 v[152:155], v241, s[48:51], s14 offen offset:1024 sc1
    buffer_load_dwordx4 v[160:163], v241, s[48:51], s14 offen offset:2048 sc1
    buffer_load_dwordx4 v[168:171], v241, s[48:51], s14 offen offset:3072 sc1
    buffer_load_dwordx4 v[116:119], v241, s[48:51], s13 offen offset:0 sc1
    buffer_load_dwordx4 v[124:127], v241, s[48:51], s13 offen offset:1024 sc1
    buffer_load_dwordx4 v[132:135], v241, s[48:51], s13 offen offset:2048 sc1
    buffer_load_dwordx4 v[140:143], v241, s[48:51], s13 offen offset:3072 sc1
    buffer_load_dwordx4 v[148:151], v241, s[48:51], s15 offen offset:0 sc1
    buffer_load_dwordx4 v[156:159], v241, s[48:51], s15 offen offset:1024 sc1
    buffer_load_dwordx4 v[164:167], v241, s[48:51], s15 offen offset:2048 sc1
    buffer_load_dwordx4 v[172:175], v241, s[48:51], s15 offen offset:3072 sc1
    s_branch L_wb2
L_rb4:
    s_add_u32 s70, s70, 1
    s_cmp_ge_u32 s70, 4000
    s_cbranch_scc1 L_kb4
    s_waitcnt vmcnt(0)
    s_sleep 4
    buffer_load_dwordx4 v[144:147], v241, s[48:51], s14 offen offset:0 sc1
    buffer_load_dwordx4 v[152:155], v241, s[48:51], s14 offen offset:1024 sc1
    buffer_load_dwordx4 v[160:163], v241, s[48:51], s14 offen offset:2048 sc1
    buffer_load_dwordx4 v[168:171], v241, s[48:51], s14 offen offset:3072 sc1
    buffer_load_dwordx4 v[116:119], v241, s[48:51], s13 offen offset:0 sc1
    buffer_load_dwordx4 v[124:127], v241, s[48:51], s13 offen offset:1024 sc1
    buffer_load_dwordx4 v[132:135], v241, s[48:51], s13 offen offset:2048 sc1
    buffer_load_dwordx4 v[140:143], v241, s[48:51], s13 offen offset:3072 sc1
    buffer_load_dwordx4 v[148:151], v241, s[48:51], s15 offen offset:0 sc1
    buffer_load_dwordx4 v[156:159], v241, s[48:51], s15 offen offset:1024 sc1
    buffer_load_dwordx4 v[164:167], v241, s[48:51], s15 offen offset:2048 sc1
    buffer_load_dwordx4 v[172:175], v241, s[48:51], s15 offen offset:3072 sc1
    s_branch L_wb4
L_rb6:
    s_add_u32 s70, s70, 1
    s_cmp_ge_u32 s70, 4000
    s_cbranch_scc1 L_kb6
    s_waitcnt vmcnt(0)
    s_sleep 4
    buffer_load_dwordx4 v[160:163], v241, s[48:51], s14 offen offset:2048 sc1
    buffer_load_dwordx4 v[168:171], v241, s[48:51], s14 offen offset:3072 sc1
    buffer_load_dwordx4 v[116:119], v241, s[48:51], s13 offen offset:0 sc1
    buffer_load_dwordx4 v[124:127], v241, s[48:51], s13 offen offset:1024 sc1
    buffer_load_dwordx4 v[132:135], v241, s[48:51], s13 offen offset:2048 sc1
    buffer_load_dwordx4 v[140:143], v241, s[48:51], s13 offen offset:3072 sc1
    buffer_load_dwordx4 v[148:151], v241, s[48:51], s15 offen offset:0 sc1
    buffer_load_dwordx4 v[156:159], v241, s[48:51], s15 offen offset:1024 sc1
    buffer_load_dwordx4 v[164:167], v241, s[48:51], s15 offen offset:2048 sc1
    buffer_load_dwordx4 v[172:175], v241, s[48:51], s15 offen offset:3072 sc1
    s_branch L_wb6
L_rb8:
    s_add_u32 s70, s70, 1
    s_cmp_ge_u32 s70, 4000
    s_cbranch_scc1 L_kb8
    s_waitcnt vmcnt(0)
    s_sleep 4
    buffer_load_dwordx4 v[116:119], v241, s[48:51], s13 offen offset:0 sc1
    buffer_load_dwordx4 v[124:127], v241, s[48:51], s13 offen offset:1024 sc1
    buffer_load_dwordx4 v[132:135], v241, s[48:51], s13 offen offset:2048 sc1
    buffer_load_dwordx4 v[140:143], v241, s[48:51], s13 offen offset:3072 sc1
    buffer_load_dwordx4 v[148:151], v241, s[48:51], s15 offen offset:0 sc1
    buffer_load_dwordx4 v[156:159], v241, s[48:51], s15 offen offset:1024 sc1
    buffer_load_dwordx4 v[164:167], v241, s[48:51], s15 offen offset:2048 sc1
    buffer_load_dwordx4 v[172:175], v241, s[48:51], s15 offen offset:3072 sc1
    s_branch L_wb8
L_rb10:
    s_add_u32 s70, s70, 1
    s_cmp_ge_u32 s70, 4000
    s_cbranch_scc1 L_kb10
    s_waitcnt vmcnt(0)
    s_sleep 4
    buffer_load_dwordx4 v[132:135], v241, s[48:51], s13 offen offset:2048 sc1
    buffer_load_dwordx4 v[140:143], v241, s[48:51], s13 offen offset:3072 sc1
    buffer_load_dwordx4 v[148:151], v241, s[48:51], s15 offen offset:0 sc1
    buffer_load_dwordx4 v[156:159], v241, s[48:51], s15 offen offset:1024 sc1
    buffer_load_dwordx4 v[164:167], v241, s[48:51], s15 offen offset:2048 sc1
    buffer_load_dwordx4 v[172:175], v241, s[48:51], s15 offen offset:3072 sc1
    s_branch L_wb10
L_rb12:
    s_add_u32 s70, s70, 1
    s_cmp_ge_u32 s70, 4000
    s_cbranch_scc1 L_kb12
    s_waitcnt vmcnt(0)
    s_sleep 4
    buffer_load_dwordx4 v[148:151], v241, s[48:51], s15 offen offset:0 sc1
    buffer_load_dwordx4 v[156:159], v241, s[48:51], s15 offen offset:1024 sc1
    buffer_load_dwordx4 v[164:167], v241, s[48:51], s15 offen offset:2048 sc1
    buffer_load_dwordx4 v[172:175], v241, s[48:51], s15 offen offset:3072 sc1
    s_branch L_wb12
L_rb14:
    s_add_u32 s70, s70, 1
    s_cmp_ge_u32 s70, 4000
    s_cbranch_scc1 L_kb14
    s_waitcnt vmcnt(0)
    s_sleep 4
    buffer_load_dwordx4 v[164:167], v241, s[48:51], s15 offen offset:2048 sc1
    buffer_load_dwordx4 v[172:175], v241, s[48:51], s15 offen offset:3072 sc1
    s_branch L_wb14
L_fb:
    s_add_u32 s52, s40, 393216
    s_addc_u32 s53, s41, 0
    s_mov_b32 s54, 262144
    s_mov_b32 s55, 0x00020000
    s_waitcnt vmcnt(0)
    v_cndmask_b32 v22, v22, 0, s[64:65]
    v_mov_b32 v15, 0xff800000
    s_mov_b32 s74, 0
L_fb1:
    buffer_load_dwordx4 v[176:179], v241, s[52:55], s74 offen offset:0 sc1
    buffer_load_dwordx4 v[180:183], v241, s[52:55], s74 offen offset:1024 sc1
    s_waitcnt vmcnt(0)
    v_mfma_f32_32x32x16_bf16 v[112:127], v[176:179], v[16:19], 0
    v_mfma_f32_32x32x16_bf16 v[112:127], v[180:183], v[20:23], v[112:127]
    s_nop 11
    v_max3_f32 v15, v15, v112, v113
    v_max3_f32 v15, v15, v114, v115
    v_max3_f32 v15, v15, v116, v117
    v_max3_f32 v15, v15, v118, v119
    v_max3_f32 v15, v15, v120, v121
    v_max3_f32 v15, v15, v122, v123
    v_max3_f32 v15, v15, v124, v125
    v_max3_f32 v15, v15, v126, v127
    s_addk_i32 s74, 4096
    s_cmp_lt_u32 s74, 262144
    s_cbranch_scc1 L_fb1
    v_mov_b32 v14, v15
    s_nop 1
    v_permlane32_swap_b32 v14, v15
    v_max_f32 v15, v14, v15
    s_mov_b32 s74, 0
    v_mov_b32 v48, 0
    v_mov_b32 v49, 0
    v_mov_b32 v50, 0
    v_mov_b32 v51, 0
    v_mov_b32 v52, 0
    v_mov_b32 v53, 0
    v_mov_b32 v54, 0
    v_mov_b32 v55, 0
    v_mov_b32 v56, 0
    v_mov_b32 v57, 0
    v_mov_b32 v58, 0
    v_mov_b32 v59, 0
    v_mov_b32 v60, 0
    v_mov_b32 v61, 0
    v_mov_b32 v62, 0
    v_mov_b32 v63, 0
L_fb2:
    buffer_load_dwordx4 v[176:179], v241, s[52:55], s74 offen offset:0 sc1
    buffer_load_dwordx4 v[180:183], v241, s[52:55], s74 offen offset:1024 sc1
    buffer_load_dwordx4 v[184:187], v241, s[52:55], s74 offen offset:2048 sc1
    buffer_load_dwordx4 v[188:191], v241, s[52:55], s74 offen offset:3072 sc1
    s_waitcnt vmcnt(0)
    v_mfma_f32_32x32x16_bf16 v[112:127], v[176:179], v[16:19], 0
    v_mfma_f32_32x32x16_bf16 v[112:127], v[180:183], v[20:23], v[112:127]
    s_nop 11
    v_sub_f32 v112, v112, v15
    v_sub_f32 v113, v113, v15
    v_sub_f32 v114, v114, v15
    v_sub_f32 v115, v115, v15
    v_sub_f32 v116, v116, v15
    v_sub_f32 v117, v117, v15
    v_sub_f32 v118, v118, v15
    v_sub_f32 v119, v119, v15
    v_sub_f32 v120, v120, v15
    v_sub_f32 v121, v121, v15
    v_sub_f32 v122, v122, v15
    v_sub_f32 v123, v123, v15
    v_sub_f32 v124, v124, v15
    v_sub_f32 v125, v125, v15
    v_sub_f32 v126, v126, v15
    v_sub_f32 v127, v127, v15
    v_exp_f32 v112, v112
    v_exp_f32 v113, v113
    v_exp_f32 v114, v114
    v_exp_f32 v115, v115
    v_exp_f32 v116, v116
    v_exp_f32 v117, v117
    v_exp_f32 v118, v118
    v_exp_f32 v119, v119
    v_exp_f32 v120, v120
    v_exp_f32 v121, v121
    v_exp_f32 v122, v122
    v_exp_f32 v123, v123
    v_exp_f32 v124, v124
    v_exp_f32 v125, v125
    v_exp_f32 v126, v126
    v_exp_f32 v127, v127
    v_smfmac_f32_32x32x32_bf16 v[48:63], v[184:187], v[112:119], v240
    s_nop 0
    v_smfmac_f32_32x32x32_bf16 v[48:63], v[188:191], v[120:127], v240
    s_addk_i32 s74, 4096
    s_cmp_lt_u32 s74, 262144
    s_cbranch_scc1 L_fb2
    s_nop 11
    v_rcp_f32 v14, v55
    s_nop 0
    v_mul_f32 v14, v14, v13
    s_branch L_fbret
.section .rodata,"a"
.p2align 6
.amdhsa_kernel gated_mix__linear_kernel_hedgehog__grouped_kv_mqa__prompt_kernel
  .amdhsa_next_free_vgpr 256
  .amdhsa_next_free_sgpr 102
  .amdhsa_accum_offset 256
  .amdhsa_group_segment_fixed_size 0
  .amdhsa_kernarg_size 104
  .amdhsa_user_sgpr_count 2
  .amdhsa_user_sgpr_kernarg_segment_ptr 1
  .amdhsa_system_sgpr_workgroup_id_x 1
.end_amdhsa_kernel
```
